```python
import torch

def _softmax(x, axis=-1):
    return torch.softmax(x, dim=axis)
def _gelu(x):
    return torch.nn.functional.gelu(x, approximate="tanh")
def _silu(x):
    return torch.nn.functional.silu(x)
def _sigmoid(x):
    return torch.sigmoid(x)
def _layernorm(x, axis=-1, eps=1e-5):
    m = x.mean(dim=axis, keepdim=True)
    v = x.var(dim=axis, keepdim=True, unbiased=False)
    return (x - m) / torch.sqrt(v + eps)
def _scatter_add(tgt, idx, src, axis=0):
    return tgt.clone().index_add_(axis, idx, src)
def _segment_sum(src, seg, n):
    out = torch.zeros((n,) + src.shape[1:], dtype=src.dtype)
    return out.index_add_(0, seg, src)
def _pad(x, pw):
    flat = tuple(v for pair in reversed(pw) for v in pair)
    return torch.nn.functional.pad(x, flat)

kernel_name = 'sequential_preLN__sliding_block_cached__mixer_channel_mlp__decode'

def setup_inputs():

    _w = (lambda a: (lambda t: t.to(torch.bfloat16) if t.is_floating_point() else t)(torch.as_tensor(a)))
    def _A_setup():
        B, Sq, D = 8, 1, 512
        Hq, Hkv, Sk, Dh = 32, 8, 4096, 128
        assert Hq % Hkv == 0, (Hq, Hkv)
        return {
            "x": _w((lambda *s: torch.randn(*s, dtype=torch.bfloat16) * 0.05)(B, Sq, D)),
            "k_cache": _w((lambda *s: torch.randn(*s, dtype=torch.bfloat16) * 3.2)(B, Hkv, Sk, Dh)),
            "v_cache": _w((lambda *s: torch.randn(*s, dtype=torch.bfloat16) * 0.4)(B, Hkv, Sk, Dh)),
            "wq": _w((lambda *s: torch.randn(*s, dtype=torch.bfloat16) * 3.2)(D, Hq * Dh) * (D ** -0.5)),
            "wo": _w((lambda *s: torch.randn(*s, dtype=torch.bfloat16) * 0.4)(Hq * Dh, D) * ((Hq * Dh) ** -0.5)),
        }
    _A_in = _A_setup()

    def _B_setup():
        B, S, D, F = 8, 1, 512, 1792
        return {
            "x": _w((lambda *s: torch.randn(*s, dtype=torch.bfloat16) * 0.05)(B, S, D)),
            "w1": _w((lambda *s: torch.randn(*s, dtype=torch.bfloat16) * 3.2)(D, F) * (D ** -0.5)),
            "b1": _w((lambda *s: torch.randn(*s, dtype=torch.bfloat16) * 1.6)(F)),
            "w2": _w((lambda *s: torch.randn(*s, dtype=torch.bfloat16) * 0.2)(F, D) * (F ** -0.5)),
            "b2": _w((lambda *s: torch.randn(*s, dtype=torch.bfloat16) * 0.4)(D)),
        }
    _B_in = _B_setup()

    return {
        "A_x": _A_in["x"],
        "A_k_cache": _A_in["k_cache"],
        "A_v_cache": _A_in["v_cache"],
        "A_wq": _A_in["wq"],
        "A_wo": _A_in["wo"],
        "B_x": _B_in["x"],
        "B_w1": _B_in["w1"],
        "B_b1": _B_in["b1"],
        "B_w2": _B_in["w2"],
        "B_b2": _B_in["b2"],
    }

def reference(A_x, A_k_cache, A_v_cache, A_wq, A_wo, B_x, B_w1, B_b1, B_w2, B_b2):
    def _A_ref(x, k_cache, v_cache, wq, wo):
        B, Sq, D = x.shape
        Hq, Dh = 32, 128
        Hkv, Sk = k_cache.shape[1], k_cache.shape[2]
        W = min(4096, max(256, Sk // 4))
        rep = Hq // Hkv
        q = (lambda x, *d: x.permute(*d))((x @ wq).reshape(B, Sq, Hq, Dh), 0, 2, 1, 3)
        k = (lambda x, n, axis: torch.repeat_interleave(x, n, dim=axis))(k_cache[:, :, Sk - W:, :], rep, axis=1)
        v = (lambda x, n, axis: torch.repeat_interleave(x, n, dim=axis))(v_cache[:, :, Sk - W:, :], rep, axis=1)
        scores = torch.einsum("bhqd,bhkd->bhqk", q, k) * (Dh ** -0.5)
        p = _softmax(scores, axis=-1)
        o = torch.einsum("bhqk,bhkd->bhqd", p, v)
        return (lambda x, *d: x.permute(*d))(o, 0, 2, 1, 3).reshape(B, Sq, Hq * Dh) @ wo

    def _B_ref(x, w1, b1, w2, b2):
        y = _layernorm(x, axis=-1)
        h = _gelu(torch.einsum("bsd,df->bsf", y, w1) + b1)
        return torch.einsum("bsf,fd->bsd", h, w2) + b2

    x = A_x
    h = x + _A_ref(_layernorm(x, axis=-1), A_k_cache, A_v_cache, A_wq, A_wo)
    h2 = h + _B_ref(_layernorm(h, axis=-1), B_w1, B_b1, B_w2, B_b2)
    return h2
```

```asm
; @launch grid=(256,1,1) block=(512,1,1) lds=156416
.amdgcn_target "amdgcn-amd-amdhsa--gfx950"
.text
.globl sequential_preLN__sliding_block_cached__mixer_channel_mlp__decode_kernel
.p2align 8
.type sequential_preLN__sliding_block_cached__mixer_channel_mlp__decode_kernel,@function
sequential_preLN__sliding_block_cached__mixer_channel_mlp__decode_kernel:
    s_cmp_ge_u32 s2, 256
    s_cbranch_scc1 L_END
    s_load_dwordx16 s[64:79], s[0:1], 0
    s_load_dwordx2 s[88:89], s[0:1], 96
    s_load_dwordx8 s[80:87], s[0:1], 64
    v_lshrrev_b32 v1, 6, v0
    v_and_b32 v0, 63, v0
    v_readfirstlane_b32 s3, v1
    v_mov_b32 v1, 0
    v_lshrrev_b32 v2, 4, v0
    v_and_b32 v3, 15, v0
    v_mov_b32 v4, 147456
    v_mov_b32 v5, 1
    s_and_b32 s4, s2, 7
    s_lshr_b32 s5, s2, 5
    s_bfe_u32 s6, s2, 0x20003
    s_mov_b32 s53, 400000
    s_and_b32 s7, s3, 3
    s_lshl_b32 s60, s7, 2
    v_add_u32 v7, s60, v4
    v_lshlrev_b32 v12, 4, v0
    v_mov_b32 v238, 0x7fff0000
    s_lshl_b32 s58, s5, 3
    s_add_u32 s58, s58, s4
    s_mov_b32 s63, s58
    s_lshl_b32 s58, s58, 20
    s_lshl_b32 s59, s6, 16
    s_add_u32 s58, s58, s59
    s_add_u32 s58, s58, 786432
    s_mov_b32 s10, 268435456
    s_mov_b32 s11, 0x20000
    s_mov_b32 s22, 8192
    s_mov_b32 s23, 0x20000
    s_mov_b32 s14, 67108864
    s_mov_b32 s15, 0x20000
    s_mov_b32 s26, 4194304
    s_mov_b32 s27, 0x20000
    s_cmp_ge_u32 s3, 4
    s_cbranch_scc1 L_VW
    s_setprio 2
    s_lshl_b32 s61, s3, 10
    s_lshl_b32 s60, s3, 14
    s_add_u32 s59, s60, s58
    s_add_u32 m0, s60, 65536
    v_xor_b32 v16, 0, v2
    v_xor_b32 v16, v16, v3
    v_lshlrev_b32 v16, 4, v16
    v_lshl_add_u32 v16, v2, 8, v16
    v_xor_b32 v17, 4, v2
    v_xor_b32 v17, v17, v3
    v_lshlrev_b32 v17, 4, v17
    v_lshl_add_u32 v17, v2, 8, v17
    v_xor_b32 v18, 8, v2
    v_xor_b32 v18, v18, v3
    v_lshlrev_b32 v18, 4, v18
    v_lshl_add_u32 v18, v2, 8, v18
    v_xor_b32 v19, 12, v2
    v_xor_b32 v19, v19, v3
    v_lshlrev_b32 v19, 4, v19
    v_lshl_add_u32 v19, v2, 8, v19
    s_waitcnt lgkmcnt(0)
    s_mov_b32 s12, s66
    s_and_b32 s13, s67, 0xffff
    s_barrier
    buffer_load_dwordx4 v16, s[12:15], s59 offen nt lds
    s_add_u32 m0, m0, 1024
    s_add_u32 s59, s59, 1024
    buffer_load_dwordx4 v17, s[12:15], s59 offen nt lds
    s_add_u32 m0, m0, 1024
    s_add_u32 s59, s59, 1024
    buffer_load_dwordx4 v18, s[12:15], s59 offen nt lds
    s_add_u32 m0, m0, 1024
    s_add_u32 s59, s59, 1024
    buffer_load_dwordx4 v19, s[12:15], s59 offen nt lds
    s_add_u32 m0, m0, 1024
    s_add_u32 s59, s59, 1024
    buffer_load_dwordx4 v16, s[12:15], s59 offen nt lds
    s_add_u32 m0, m0, 1024
    s_add_u32 s59, s59, 1024
    buffer_load_dwordx4 v17, s[12:15], s59 offen nt lds
    s_branch L_K_MAIN
L_VW:
    s_setprio 3
    s_cmp_lg_u32 s7, 0
    s_cbranch_scc1 L_V_NZ
    v_lshl_add_u32 v13, v0, 2, v4
    v_mov_b32 v14, 1.0
    v_cmp_eq_u32 vcc, 40, v0
    s_nop 1
    v_cndmask_b32 v14, 0, v14, vcc
    ds_write_b32 v13, v14
    ds_write_b32 v13, v1 offset:256
    ds_write_b32 v13, v1 offset:512
L_V_NZ:
    s_lshl_b32 s60, s7, 12
    s_add_u32 m0, s60, 131072
    s_lshl_b32 s59, s4, 10
    s_lshl_b32 s60, s5, 7
    s_add_u32 s59, s59, s60
    s_lshl_b32 s60, s6, 20
    s_add_u32 s59, s59, s60
    s_lshl_b32 s60, s7, 18
    s_add_u32 s59, s59, s60
    v_lshrrev_b32 v74, 3, v0
    v_mul_u32_u24 v74, 8192, v74
    v_bfe_u32 v14, v0, 4, 1
    v_lshlrev_b32 v14, 1, v14
    v_and_b32 v75, 7, v0
    v_xor_b32 v14, v14, v75
    v_xor_b32 v75, 4, v14
    v_lshl_add_u32 v75, v75, 4, v74
    v_lshl_add_u32 v74, v14, 4, v74
    v_lshrrev_b32 v15, 5, v0
    v_lshlrev_b32 v15, 10, v15
    v_and_b32 v14, 31, v0
    v_lshl_add_u32 v15, v14, 3, v15
    s_lshl_b32 s60, s6, 8
    v_add_u32 v15, s60, v15
    s_lshl_b32 s60, s7, 11
    s_lshl_b32 s61, s3, 10
    s_waitcnt lgkmcnt(0)
    s_mov_b32 s20, s64
    s_and_b32 s21, s65, 0xffff
    s_mov_b32 s24, s70
    s_and_b32 s25, s71, 0xffff
    s_mov_b32 s8, s88
    s_and_b32 s9, s89, 0xffff
    s_lshl_b32 s54, s4, 5
    s_add_u32 s54, s54, s4
    s_add_u32 s54, s54, 24
    s_sub_u32 s54, s54, s2
    s_xor_b32 s55, s3, 5
    s_or_b32 s74, s54, s55
    s_cbranch_scc1 L_V_NOZ
    v_mov_b32 v76, 0
    v_mov_b32 v77, 0
    v_mov_b32 v78, 0
    v_mov_b32 v79, 0
    s_mul_i32 s54, s5, 3072
    s_add_u32 s54, s54, 32768
    buffer_store_dwordx4 v[76:79], v12, s[8:11], s54 offen offset:0 sc1
    buffer_store_dwordx4 v[76:79], v12, s[8:11], s54 offen offset:1024 sc1
    buffer_store_dwordx4 v[76:79], v12, s[8:11], s54 offen offset:2048 sc1
    s_add_u32 s54, s54, 196608
    buffer_store_dwordx4 v[76:79], v12, s[8:11], s54 offen offset:0 sc1
    buffer_store_dwordx4 v[76:79], v12, s[8:11], s54 offen offset:1024 sc1
    buffer_store_dwordx4 v[76:79], v12, s[8:11], s54 offen offset:2048 sc1
L_V_NOZ:
    buffer_load_dwordx4 v[16:19], v12, s[20:23], s60 offen
    buffer_load_dwordx4 v[20:23], v12, s[20:23], s60 offen offset:1024
    buffer_load_dwordx2 v[64:65], v15, s[20:23], s60 offen
    buffer_load_dwordx4 v74, s[24:27], s59 offen nt lds
    s_add_u32 m0, m0, 1024
    s_add_u32 s59, s59, 65536
    buffer_load_dwordx4 v75, s[24:27], s59 offen nt lds
    s_add_u32 m0, m0, 1024
    s_add_u32 s59, s59, 65536
    buffer_load_dwordx4 v74, s[24:27], s59 offen nt lds
    s_add_u32 m0, m0, 1024
    s_add_u32 s59, s59, 65536
    buffer_load_dwordx4 v75, s[24:27], s59 offen nt lds
    buffer_load_dword v6, v1, s[8:11], 0 offen sc1
    s_barrier
    s_mul_i32 s60, s7, 2080
    s_add_u32 s60, s60, 148096
    v_lshrrev_b32 v15, 5, v0
    v_mul_u32_u24 v15, 1040, v15
    v_and_b32 v14, 31, v0
    v_lshl_add_u32 v15, v14, 3, v15
    v_add_u32 v15, s60, v15
    s_mov_b32 s98, 0
    s_mov_b32 s99, -1
    s_lshl_b32 s60, s7, 1
    v_bfe_u32 v14, v0, 2, 2
    v_lshrrev_b32 v24, 1, v14
    v_and_b32 v70, 1, v2
    v_lshl_add_u32 v24, v70, 1, v24
    v_lshlrev_b32 v24, 1, v24
    v_bfe_u32 v70, v0, 1, 1
    v_xor_b32 v24, v24, v70
    v_xor_b32 v24, s60, v24
    v_lshl_add_u32 v14, v2, 3, v14
    v_mul_u32_u24 v14, 128, v14
    v_lshl_add_u32 v14, v24, 4, v14
    v_and_b32 v24, 1, v0
    v_lshl_add_u32 v70, v24, 3, v14
    v_add_u32 v70, 131072, v70
    v_and_b32 v14, 7, v0
    v_mul_u32_u24 v71, 1040, v14
    v_lshl_add_u32 v71, v2, 4, v71
    v_add_u32 v71, 148096, v71
    v_and_b32 v72, 7, v0
    v_lshlrev_b32 v72, 17, v72
    v_lshl_add_u32 v72, v2, 5, v72
    v_bfe_u32 v14, v0, 3, 1
    v_lshl_add_u32 v72, v14, 4, v72
    s_lshl_b32 s62, s4, 2
    s_add_u32 s62, s62, s6
    s_lshl_b32 s62, s62, 12
    s_lshl_b32 s60, s5, 9
    s_add_u32 s62, s62, s60
    s_lshl_b32 s60, s7, 7
    s_add_u32 s62, s62, s60
    s_add_u32 s62, s62, 262144
    s_mov_b32 s100, 0xff00ff00
    s_mov_b32 s101, 0xff00ff00
    s_waitcnt vmcnt(6)
    v_lshlrev_b32 v24, 16, v16
    v_lshlrev_b32 v32, 16, v20
    v_and_b32 v25, 0xffff0000, v16
    v_and_b32 v33, 0xffff0000, v20
    v_lshlrev_b32 v26, 16, v17
    v_lshlrev_b32 v34, 16, v21
    v_and_b32 v27, 0xffff0000, v17
    v_and_b32 v35, 0xffff0000, v21
    v_lshlrev_b32 v28, 16, v18
    v_lshlrev_b32 v36, 16, v22
    v_and_b32 v29, 0xffff0000, v18
    v_and_b32 v37, 0xffff0000, v22
    v_lshlrev_b32 v30, 16, v19
    v_lshlrev_b32 v38, 16, v23
    v_and_b32 v31, 0xffff0000, v19
    v_and_b32 v39, 0xffff0000, v23
    v_readfirstlane_b32 s55, v24
    v_readfirstlane_b32 s94, v32
    s_nop 0
    v_mov_b32 v50, s55
    v_mov_b32 v62, s94
    v_mov_b32 v51, s55
    v_mov_b32 v63, s94
    v_pk_add_f32 v[40:41], v[24:25], v[50:51] neg_lo:[0,1] neg_hi:[0,1]
    v_pk_add_f32 v[52:53], v[32:33], v[62:63] neg_lo:[0,1] neg_hi:[0,1]
    v_pk_add_f32 v[42:43], v[26:27], v[50:51] neg_lo:[0,1] neg_hi:[0,1]
    v_pk_add_f32 v[54:55], v[34:35], v[62:63] neg_lo:[0,1] neg_hi:[0,1]
    v_pk_add_f32 v[44:45], v[28:29], v[50:51] neg_lo:[0,1] neg_hi:[0,1]
    v_pk_add_f32 v[56:57], v[36:37], v[62:63] neg_lo:[0,1] neg_hi:[0,1]
    v_pk_add_f32 v[46:47], v[30:31], v[50:51] neg_lo:[0,1] neg_hi:[0,1]
    v_pk_add_f32 v[58:59], v[38:39], v[62:63] neg_lo:[0,1] neg_hi:[0,1]
    v_pk_add_f32 v[48:49], v[40:41], v[42:43]
    v_pk_add_f32 v[60:61], v[52:53], v[54:55]
    v_pk_mul_f32 v[50:51], v[40:41], v[40:41]
    v_pk_mul_f32 v[62:63], v[52:53], v[52:53]
    v_pk_add_f32 v[40:41], v[44:45], v[46:47]
    v_pk_add_f32 v[52:53], v[56:57], v[58:59]
    v_pk_fma_f32 v[50:51], v[42:43], v[42:43], v[50:51]
    v_pk_fma_f32 v[62:63], v[54:55], v[54:55], v[62:63]
    v_pk_fma_f32 v[50:51], v[44:45], v[44:45], v[50:51]
    v_pk_fma_f32 v[62:63], v[56:57], v[56:57], v[62:63]
    v_pk_fma_f32 v[50:51], v[46:47], v[46:47], v[50:51]
    v_pk_fma_f32 v[62:63], v[58:59], v[58:59], v[62:63]
    v_pk_add_f32 v[48:49], v[48:49], v[40:41]
    v_pk_add_f32 v[60:61], v[60:61], v[52:53]
    v_add_f32 v50, v50, v51
    v_add_f32 v62, v62, v63
    v_add_f32 v48, v48, v49
    v_add_f32 v60, v60, v61
    s_nop 0
    v_add_f32_dpp v48, v48, v48 quad_perm:[1,0,3,2] row_mask:0xf bank_mask:0xf
    v_add_f32_dpp v60, v60, v60 quad_perm:[1,0,3,2] row_mask:0xf bank_mask:0xf
    v_add_f32_dpp v50, v50, v50 quad_perm:[1,0,3,2] row_mask:0xf bank_mask:0xf
    v_add_f32_dpp v62, v62, v62 quad_perm:[1,0,3,2] row_mask:0xf bank_mask:0xf
    v_add_f32_dpp v48, v48, v48 quad_perm:[2,3,0,1] row_mask:0xf bank_mask:0xf
    v_add_f32_dpp v60, v60, v60 quad_perm:[2,3,0,1] row_mask:0xf bank_mask:0xf
    v_add_f32_dpp v50, v50, v50 quad_perm:[2,3,0,1] row_mask:0xf bank_mask:0xf
    v_add_f32_dpp v62, v62, v62 quad_perm:[2,3,0,1] row_mask:0xf bank_mask:0xf
    v_add_f32_dpp v48, v48, v48 row_half_mirror row_mask:0xf bank_mask:0xf
    v_add_f32_dpp v60, v60, v60 row_half_mirror row_mask:0xf bank_mask:0xf
    v_add_f32_dpp v50, v50, v50 row_half_mirror row_mask:0xf bank_mask:0xf
    v_add_f32_dpp v62, v62, v62 row_half_mirror row_mask:0xf bank_mask:0xf
    v_add_f32_dpp v48, v48, v48 row_mirror row_mask:0xf bank_mask:0xf
    v_add_f32_dpp v60, v60, v60 row_mirror row_mask:0xf bank_mask:0xf
    v_add_f32_dpp v50, v50, v50 row_mirror row_mask:0xf bank_mask:0xf
    v_add_f32_dpp v62, v62, v62 row_mirror row_mask:0xf bank_mask:0xf
    v_add_f32_dpp v48, v48, v48 row_bcast:15 row_mask:0xa bank_mask:0xf
    v_add_f32_dpp v60, v60, v60 row_bcast:15 row_mask:0xa bank_mask:0xf
    v_add_f32_dpp v50, v50, v50 row_bcast:15 row_mask:0xa bank_mask:0xf
    v_add_f32_dpp v62, v62, v62 row_bcast:15 row_mask:0xa bank_mask:0xf
    v_add_f32_dpp v48, v48, v48 row_bcast:31 row_mask:0xc bank_mask:0xf
    v_add_f32_dpp v60, v60, v60 row_bcast:31 row_mask:0xc bank_mask:0xf
    v_add_f32_dpp v50, v50, v50 row_bcast:31 row_mask:0xc bank_mask:0xf
    v_add_f32_dpp v62, v62, v62 row_bcast:31 row_mask:0xc bank_mask:0xf
    v_readlane_b32 s56, v48, 63
    v_readlane_b32 s95, v60, 63
    v_readlane_b32 s57, v50, 63
    v_readlane_b32 s96, v62, 63
    v_mov_b32 v42, 0x3b000000
    v_mov_b32 v54, 0x3b000000
    v_mul_f32 v40, s56, v42
    v_mul_f32 v52, s95, v54
    v_mul_f32 v41, s57, v42
    v_mul_f32 v53, s96, v54
    v_fma_f32 v41, -v40, v40, v41
    v_fma_f32 v53, -v52, v52, v53
    v_max_f32 v41, 0, v41
    v_max_f32 v53, 0, v53
    v_add_f32 v40, s55, v40
    v_add_f32 v52, s94, v52
    v_cndmask_b32 v40, v40, v52, s[98:99]
    v_cndmask_b32 v41, v41, v53, s[98:99]
    v_cvt_pk_bf16_f32 v42, v40, v41
    v_lshlrev_b32 v40, 16, v42
    v_and_b32 v41, 0xffff0000, v42
    v_add_f32 v41, 0x3727c5ac, v41
    v_cvt_pk_bf16_f32 v42, v41, v41
    v_lshlrev_b32 v41, 16, v42
    v_sqrt_f32 v41, v41
    s_nop 0
    v_cvt_pk_bf16_f32 v42, v41, v41
    v_lshlrev_b32 v41, 16, v42
    v_rcp_f32 v42, v41
    s_nop 0
    v_fma_f32 v43, -v41, v42, 1.0
    v_fma_f32 v42, v43, v42, v42
    s_waitcnt vmcnt(5)
    v_lshlrev_b32 v66, 16, v64
    v_and_b32 v67, 0xffff0000, v64
    v_lshlrev_b32 v68, 16, v65
    v_and_b32 v69, 0xffff0000, v65
    v_sub_f32 v66, v66, v40
    v_sub_f32 v67, v67, v40
    v_sub_f32 v68, v68, v40
    v_sub_f32 v69, v69, v40
    v_cvt_pk_bf16_f32 v44, v66, v67
    v_lshlrev_b32 v66, 16, v44
    v_and_b32 v67, 0xffff0000, v44
    v_cvt_pk_bf16_f32 v45, v68, v69
    v_lshlrev_b32 v68, 16, v45
    v_and_b32 v69, 0xffff0000, v45
    v_mul_f32 v44, v66, v42
    v_mul_f32 v45, v67, v42
    v_mul_f32 v46, v68, v42
    v_mul_f32 v47, v69, v42
    v_fma_f32 v66, -v44, v41, v66
    v_fma_f32 v67, -v45, v41, v67
    v_fma_f32 v68, -v46, v41, v68
    v_fma_f32 v69, -v47, v41, v69
    v_fma_f32 v66, v66, v42, v44
    v_fma_f32 v67, v67, v42, v45
    v_fma_f32 v68, v68, v42, v46
    v_fma_f32 v69, v69, v42, v47
    v_cvt_pk_bf16_f32 v44, v66, v67
    v_cvt_pk_bf16_f32 v45, v68, v69
    ds_write_b64 v15, v[44:45]
    s_waitcnt vmcnt(1)
    ds_write_b32 v7, v5 offset:16
    s_waitcnt vmcnt(0)
    s_mov_b32 s60, 0x9e3779b1
    v_mul_lo_u32 v53, v6, s60
    v_add_u32 v53, 0x7f4a7c15, v53
    v_mov_b32 v55, v53
    v_readfirstlane_b32 s52, v53
    s_cmp_lg_u32 s74, 0
    s_cbranch_scc1 L_V_NOZF
    s_lshl_b32 s60, s5, 7
    s_add_u32 s60, s60, 1024
    s_mov_b64 exec, 1
    buffer_store_dword v53, v1, s[8:11], s60 offen sc1
    s_mov_b64 exec, -1
L_V_NOZF:
W4_1:
    ds_read_b128 v[16:19], v4 offset:16
    s_sub_u32 s53, s53, 1
    s_cbranch_scc1 L_END
    s_waitcnt lgkmcnt(0)
    v_min3_u32 v16, v16, v17, v18
    v_min_u32 v16, v16, v19
    s_nop 0
    v_readfirstlane_b32 s54, v16
    s_nop 0
    s_cmp_lt_u32 s54, 1
    s_cbranch_scc1 W4_1
    ds_read_b128 v[16:19], v71 offset:0
    ds_read_b64_tr_b16 v[32:33], v70 offset:0
    ds_read_b64_tr_b16 v[34:35], v70 offset:512
    ds_read_b128 v[20:23], v71 offset:64
    ds_read_b64_tr_b16 v[36:37], v70 offset:4096
    ds_read_b64_tr_b16 v[38:39], v70 offset:4608
    ds_read_b128 v[24:27], v71 offset:128
    ds_read_b64_tr_b16 v[40:41], v70 offset:8192
    ds_read_b64_tr_b16 v[42:43], v70 offset:8704
    ds_read_b128 v[28:31], v71 offset:192
    ds_read_b64_tr_b16 v[44:45], v70 offset:12288
    ds_read_b64_tr_b16 v[46:47], v70 offset:12800
    s_waitcnt lgkmcnt(9)
    v_mfma_f32_16x16x32_bf16 v[56:59], v[32:35], v[16:19], 0
    s_waitcnt lgkmcnt(6)
    v_mfma_f32_16x16x32_bf16 v[56:59], v[36:39], v[20:23], v[56:59]
    s_waitcnt lgkmcnt(3)
    v_mfma_f32_16x16x32_bf16 v[56:59], v[40:43], v[24:27], v[56:59]
    s_waitcnt lgkmcnt(0)
    v_mfma_f32_16x16x32_bf16 v[56:59], v[44:47], v[28:31], v[56:59]
    ds_write_b32 v4, v53 offset:0
    s_nop 6
    v_cndmask_b32 v52, v56, v58, s[100:101]
    v_cndmask_b32 v54, v57, v59, s[100:101]
    buffer_store_dwordx4 v[52:55], v72, s[8:11], s62 offen sc1
    s_cmp_lg_u32 s7, 0
    s_cbranch_scc1 L_V_NOXC
    s_getreg_b32 s60, hwreg(HW_REG_XCC_ID, 0, 4)
    v_mov_b32 v56, s60
    v_mov_b32 v57, v53
    s_lshl_b32 s60, s4, 5
    s_lshr_b32 s59, s2, 3
    s_add_u32 s60, s60, s59
    s_lshl_b32 s60, s60, 3
    s_add_u32 s60, s60, 196608
    s_mov_b64 exec, 1
    buffer_store_dwordx2 v[56:57], v1, s[8:11], s60 offen sc1
    s_mov_b64 exec, -1
L_V_NOXC:
    s_lshl_b32 s59, s63, 14
    s_lshl_b32 s60, s7, 10
    s_add_u32 s59, s59, s60
    s_add_u32 s64, s59, 262144
    s_add_u32 s65, s64, 4096
    s_add_u32 s66, s65, 4096
    s_add_u32 s67, s66, 4096
    s_lshl_b32 s60, s7, 8
    s_add_u32 s60, s60, 131072
    v_lshl_add_u32 v73, v0, 2, s60
    s_waitcnt vmcnt(0)
    ds_write_b32 v7, v5 offset:32
W4_2:
    ds_read_b128 v[16:19], v4 offset:32
    s_sub_u32 s53, s53, 1
    s_cbranch_scc1 L_END
    s_waitcnt lgkmcnt(0)
    v_min3_u32 v16, v16, v17, v18
    v_min_u32 v16, v16, v19
    s_nop 0
    v_readfirstlane_b32 s54, v16
    s_nop 0
    s_cmp_lt_u32 s54, 1
    s_cbranch_scc1 W4_2
    s_sleep 10
    v_mov_b32 v74, v12
L_QG:
    buffer_load_dwordx4 v[32:35], v74, s[8:11], s64 offen sc1
    buffer_load_dwordx4 v[36:39], v74, s[8:11], s65 offen sc1
    buffer_load_dwordx4 v[40:43], v74, s[8:11], s66 offen sc1
    buffer_load_dwordx4 v[44:47], v74, s[8:11], s67 offen sc1
    ds_write_b32 v7, v5 offset:544
    s_sub_u32 s53, s53, 1
    s_cbranch_scc1 L_END
    s_waitcnt vmcnt(0)
    v_bitop3_b32 v48, v33, s52, 0 bitop3:0xbe
    v_bitop3_b32 v49, v35, s52, 0 bitop3:0xbe
    v_bitop3_b32 v48, v37, s52, v48 bitop3:0xbe
    v_bitop3_b32 v49, v39, s52, v49 bitop3:0xbe
    v_bitop3_b32 v48, v41, s52, v48 bitop3:0xbe
    v_bitop3_b32 v49, v43, s52, v49 bitop3:0xbe
    v_bitop3_b32 v48, v45, s52, v48 bitop3:0xbe
    v_bitop3_b32 v49, v47, s52, v49 bitop3:0xbe
    v_or_b32 v48, v48, v49
    v_cmp_ne_u32 vcc, 0, v48
    s_nop 0
    s_cmp_eq_u64 vcc, 0
    s_cbranch_scc0 L_QG
    v_add_f32 v48, v32, v36
    v_add_f32 v49, v34, v38
    v_add_f32 v50, v40, v44
    v_add_f32 v51, v42, v46
    v_pk_add_f32 v[48:49], v[48:49], v[50:51]
    v_cvt_pk_bf16_f32 v48, v48, v49
    ds_write_b32 v73, v48
    v_mov_b32 v14, 2
    ds_write_b32 v7, v14 offset:32
    s_setprio 1
    s_mov_b32 s16, s68
    s_and_b32 s17, s69, 0xffff
    s_mov_b32 s18, 67108864
    s_mov_b32 s19, 0x20000
    s_and_b32 s60, s7, 1
    s_lshl_b32 s60, s60, 3
    v_lshlrev_b32 v13, 1, v2
    v_or_b32 v13, s60, v13
    v_xor_b32 v13, v13, v3
    v_lshlrev_b32 v13, 4, v13
    v_lshl_add_u32 v13, v2, 8, v13
    s_lshl_b32 s60, s7, 11
    s_add_u32 s60, s60, 32768
    s_add_u32 s59, s58, s60
    s_add_u32 m0, s60, 0
W4_3:
    ds_read_b128 v[16:19], v4 offset:304
    s_sub_u32 s53, s53, 1
    s_cbranch_scc1 L_END
    s_waitcnt lgkmcnt(0)
    v_min3_u32 v16, v16, v17, v18
    v_min_u32 v16, v16, v19
    s_nop 0
    v_readfirstlane_b32 s54, v16
    s_sleep 1
    s_cmp_lt_u32 s54, 1
    s_cbranch_scc1 W4_3
    buffer_load_dwordx4 v13, s[16:19], s59 offen nt lds
    s_add_u32 m0, m0, 1024
    s_add_u32 s59, s59, 1024
    buffer_load_dwordx4 v13, s[16:19], s59 offen nt lds
    s_add_u32 m0, m0, 7168
    s_add_u32 s59, s59, 7168
    buffer_load_dwordx4 v13, s[16:19], s59 offen nt lds
    s_add_u32 m0, m0, 1024
    s_add_u32 s59, s59, 1024
    buffer_load_dwordx4 v13, s[16:19], s59 offen nt lds
    s_add_u32 m0, m0, 7168
    s_add_u32 s59, s59, 7168
    buffer_load_dwordx4 v13, s[16:19], s59 offen nt lds
    s_add_u32 m0, m0, 1024
    s_add_u32 s59, s59, 1024
    buffer_load_dwordx4 v13, s[16:19], s59 offen nt lds
    s_add_u32 m0, m0, 7168
    s_add_u32 s59, s59, 7168
    buffer_load_dwordx4 v13, s[16:19], s59 offen nt lds
    s_add_u32 m0, m0, 1024
    s_add_u32 s59, s59, 1024
    buffer_load_dwordx4 v13, s[16:19], s59 offen nt lds
    v_and_b32 v15, 3, v0
    v_mul_u32_u24 v120, 528, v15
    v_add_u32 v120, 132096, v120
    v_lshl_add_u32 v120, v2, 4, v120
    s_lshl_b32 s60, s4, 2
    v_add_u32 v121, s60, v15
    s_lshr_b32 s60, s2, 3
    v_lshlrev_b32 v121, 5, v121
    v_add_u32 v121, s60, v121
    v_lshlrev_b32 v121, 10, v121
    v_bfe_u32 v15, v0, 3, 1
    v_lshl_add_u32 v121, v15, 7, v121
    v_lshl_add_u32 v121, v2, 5, v121
    v_bfe_u32 v15, v0, 2, 1
    v_lshl_add_u32 v121, v15, 4, v121
    v_bfe_u32 v14, v0, 2, 2
    v_and_b32 v15, 1, v2
    v_lshl_add_u32 v15, v15, 2, v14
    v_lshlrev_b32 v15, 1, v15
    v_bfe_u32 v16, v0, 1, 1
    v_xor_b32 v15, v15, v16
    v_lshl_add_u32 v14, v2, 3, v14
    v_lshlrev_b32 v14, 8, v14
    v_and_b32 v16, 1, v0
    v_lshl_add_u32 v14, v16, 3, v14
    s_lshl_b32 s60, s7, 2
    v_xor_b32 v16, s60, v15
    v_lshl_add_u32 v122, v16, 4, v14
    s_lshl_b32 s60, s7, 2
    s_add_u32 s60, s60, 2
    v_xor_b32 v16, s60, v15
    v_lshl_add_u32 v123, v16, 4, v14
    s_mov_b32 s94, 0x00f000f0
    s_mov_b32 s95, 0x00f000f0
    s_mov_b32 s96, 0x0f000f00
    s_mov_b32 s97, 0x0f000f00
    s_mov_b32 s98, 0xf000f000
    s_mov_b32 s99, 0xf000f000
    s_lshl_b32 s60, s7, 8
    s_add_u32 s60, s60, 1310720
    v_mov_b32 v105, s52
    v_mov_b32 v107, s52
    s_lshl_b32 s61, s4, 5
    s_lshr_b32 s62, s2, 3
    s_add_u32 s61, s61, s62
    s_lshl_b32 s61, s61, 7
    s_add_u32 s61, s61, 3670016
    s_lshl_b32 s62, s7, 15
    s_add_u32 s61, s61, s62
W4_4:
    ds_read_b128 v[16:19], v4 offset:64
    s_sub_u32 s53, s53, 1
    s_cbranch_scc1 L_END
    s_waitcnt lgkmcnt(0)
    v_min3_u32 v16, v16, v17, v18
    v_min_u32 v16, v16, v19
    s_nop 0
    v_readfirstlane_b32 s54, v16
    s_sleep 1
    s_cmp_lt_u32 s54, 1
    s_cbranch_scc1 W4_4
    ds_read_b128 v[16:19], v120 offset:0
    ds_read_b128 v[20:23], v120 offset:64
    ds_read_b128 v[24:27], v120 offset:128
    ds_read_b128 v[28:31], v120 offset:192
    ds_read_b128 v[32:35], v120 offset:256
    ds_read_b128 v[36:39], v120 offset:320
    ds_read_b128 v[40:43], v120 offset:384
    ds_read_b128 v[44:47], v120 offset:448
W4_5:
    ds_read_b128 v[108:111], v4 offset:560
    s_sub_u32 s53, s53, 1
    s_cbranch_scc1 L_END
    s_waitcnt lgkmcnt(0)
    v_min3_u32 v108, v108, v109, v110
    v_min_u32 v108, v108, v111
    s_nop 0
    v_readfirstlane_b32 s54, v108
    s_nop 0
    s_cmp_lt_u32 s54, 1
    s_cbranch_scc1 W4_5
    ds_read_b64_tr_b16 v[48:49], v122 offset:0
    ds_read_b64_tr_b16 v[50:51], v122 offset:1024
    ds_read_b64_tr_b16 v[52:53], v123 offset:0
    ds_read_b64_tr_b16 v[54:55], v123 offset:1024
    ds_read_b64_tr_b16 v[56:57], v122 offset:8192
    ds_read_b64_tr_b16 v[58:59], v122 offset:9216
    ds_read_b64_tr_b16 v[60:61], v123 offset:8192
    ds_read_b64_tr_b16 v[62:63], v123 offset:9216
    ds_read_b64_tr_b16 v[64:65], v122 offset:16384
    ds_read_b64_tr_b16 v[66:67], v122 offset:17408
    ds_read_b64_tr_b16 v[68:69], v123 offset:16384
    ds_read_b64_tr_b16 v[70:71], v123 offset:17408
    s_waitcnt lgkmcnt(10)
    v_mfma_f32_16x16x32_bf16 v[96:99], v[48:51], v[16:19], 0
    s_waitcnt lgkmcnt(8)
    v_mfma_f32_16x16x32_bf16 v[100:103], v[52:55], v[16:19], 0
    ds_read_b64_tr_b16 v[72:73], v122 offset:24576
    ds_read_b64_tr_b16 v[74:75], v122 offset:25600
    ds_read_b64_tr_b16 v[76:77], v123 offset:24576
    ds_read_b64_tr_b16 v[78:79], v123 offset:25600
    s_waitcnt lgkmcnt(10)
    v_mfma_f32_16x16x32_bf16 v[96:99], v[56:59], v[20:23], v[96:99]
    s_waitcnt lgkmcnt(8)
    v_mfma_f32_16x16x32_bf16 v[100:103], v[60:63], v[20:23], v[100:103]
    s_waitcnt lgkmcnt(6)
    v_mfma_f32_16x16x32_bf16 v[96:99], v[64:67], v[24:27], v[96:99]
    s_waitcnt lgkmcnt(4)
    v_mfma_f32_16x16x32_bf16 v[100:103], v[68:71], v[24:27], v[100:103]
    s_waitcnt lgkmcnt(2)
    v_mfma_f32_16x16x32_bf16 v[96:99], v[72:75], v[28:31], v[96:99]
    s_waitcnt lgkmcnt(0)
    v_mfma_f32_16x16x32_bf16 v[100:103], v[76:79], v[28:31], v[100:103]
    v_mov_b32 v14, 7
    s_waitcnt vmcnt(2)
    ds_write_b32 v7, v14 offset:80
W4_6:
    ds_read_b128 v[108:111], v4 offset:80
    s_sub_u32 s53, s53, 1
    s_cbranch_scc1 L_END
    s_waitcnt lgkmcnt(0)
    v_min3_u32 v108, v108, v109, v110
    v_min_u32 v108, v108, v111
    s_nop 0
    v_readfirstlane_b32 s54, v108
    s_nop 0
    s_cmp_lt_u32 s54, 7
    s_cbranch_scc1 W4_6
    ds_read_b64_tr_b16 v[80:81], v122 offset:32768
    ds_read_b64_tr_b16 v[82:83], v122 offset:33792
    ds_read_b64_tr_b16 v[84:85], v123 offset:32768
    ds_read_b64_tr_b16 v[86:87], v123 offset:33792
    ds_read_b64_tr_b16 v[88:89], v122 offset:40960
    ds_read_b64_tr_b16 v[90:91], v122 offset:41984
    ds_read_b64_tr_b16 v[92:93], v123 offset:40960
    ds_read_b64_tr_b16 v[94:95], v123 offset:41984
    ds_read_b64_tr_b16 v[48:49], v122 offset:49152
    ds_read_b64_tr_b16 v[50:51], v122 offset:50176
    ds_read_b64_tr_b16 v[52:53], v123 offset:49152
    ds_read_b64_tr_b16 v[54:55], v123 offset:50176
    s_waitcnt lgkmcnt(10)
    v_mfma_f32_16x16x32_bf16 v[96:99], v[80:83], v[32:35], v[96:99]
    s_waitcnt lgkmcnt(8)
    v_mfma_f32_16x16x32_bf16 v[100:103], v[84:87], v[32:35], v[100:103]
    s_waitcnt lgkmcnt(6)
    v_mfma_f32_16x16x32_bf16 v[96:99], v[88:91], v[36:39], v[96:99]
    s_waitcnt lgkmcnt(4)
    v_mfma_f32_16x16x32_bf16 v[100:103], v[92:95], v[36:39], v[100:103]
    s_waitcnt lgkmcnt(2)
    v_mfma_f32_16x16x32_bf16 v[96:99], v[48:51], v[40:43], v[96:99]
    s_waitcnt lgkmcnt(0)
    v_mfma_f32_16x16x32_bf16 v[100:103], v[52:55], v[40:43], v[100:103]
    v_mov_b32 v14, 8
    s_waitcnt vmcnt(0)
    ds_write_b32 v7, v14 offset:80
W4_7:
    ds_read_b128 v[108:111], v4 offset:80
    s_sub_u32 s53, s53, 1
    s_cbranch_scc1 L_END
    s_waitcnt lgkmcnt(0)
    v_min3_u32 v108, v108, v109, v110
    v_min_u32 v108, v108, v111
    s_nop 0
    v_readfirstlane_b32 s54, v108
    s_nop 0
    s_cmp_lt_u32 s54, 8
    s_cbranch_scc1 W4_7
    s_mov_b64 exec, 1
    buffer_store_dword v105, v1, s[8:11], s61 offen sc1
    s_mov_b64 exec, -1
    ds_read_b64_tr_b16 v[56:57], v122 offset:57344
    ds_read_b64_tr_b16 v[58:59], v122 offset:58368
    ds_read_b64_tr_b16 v[60:61], v123 offset:57344
    ds_read_b64_tr_b16 v[62:63], v123 offset:58368
    s_waitcnt lgkmcnt(2)
    v_mfma_f32_16x16x32_bf16 v[96:99], v[56:59], v[44:47], v[96:99]
    s_waitcnt lgkmcnt(0)
    v_mfma_f32_16x16x32_bf16 v[100:103], v[60:63], v[44:47], v[100:103]
    v_mov_b32 v14, 9
    s_nop 4
    v_cndmask_b32 v104, v96, v98, s[94:95]
    v_cndmask_b32 v106, v97, v99, s[94:95]
    v_cndmask_b32 v104, v104, v100, s[96:97]
    v_cndmask_b32 v106, v106, v101, s[96:97]
    v_cndmask_b32 v104, v104, v102, s[98:99]
    v_cndmask_b32 v106, v106, v103, s[98:99]
    s_add_u32 s62, s60, 4194304
    buffer_store_dwordx4 v[104:107], v121, s[8:11], s62 offen
    buffer_store_dwordx4 v[104:107], v121, s[8:11], s60 offen sc1
    s_cmp_ge_u32 s6, 2
    s_cbranch_scc1 L_V_NOTWO
    s_lshl_b32 s58, s5, 1
    s_add_u32 s58, s58, s6
    s_lshl_b32 s64, s58, 3
    s_add_u32 s64, s64, s4
    s_lshl_b32 s64, s64, 7
    s_add_u32 s64, s64, 65536
    s_lshr_b32 s63, s58, 2
    s_lshl_b32 s63, s63, 2
    s_add_u32 s63, s63, s7
    s_waitcnt vmcnt(0)
    ds_write_b32 v7, v14 offset:80
    v_and_b32 v15, 7, v0
    v_mul_u32_u24 v14, 272, v15
    v_lshl_add_u32 v14, v2, 4, v14
    v_add_u32 v14, 134272, v14
    s_mul_i32 s60, s7, 1152
    s_add_u32 s60, s60, 137600
    v_and_b32 v15, 7, v0
    v_mul_u32_u24 v15, 144, v15
    v_bfe_u32 v16, v0, 3, 1
    v_lshl_add_u32 v15, v16, 6, v15
    v_lshl_add_u32 v15, v2, 4, v15
    v_add_u32 v15, s60, v15
    v_bfe_u32 v16, v0, 2, 2
    v_and_b32 v17, 3, v0
    v_mul_u32_u24 v18, 144, v2
    v_lshl_add_u32 v18, v16, 5, v18
    v_lshl_add_u32 v18, v17, 2, v18
    v_add_u32 v18, s60, v18
    v_mov_b32 v19, 147616
    v_mov_b32 v20, 147620
    v_cmp_eq_u32 s[56:57], 3, v17
    v_cmp_eq_u32 s[58:59], 2, v17
    v_add_u32 v24, 0, v18
    v_cndmask_b32 v24, v24, v19, s[56:57]
    v_add_u32 v25, 576, v18
    v_cndmask_b32 v25, v25, v19, s[56:57]
    v_add_u32 v26, 12, v18
    v_cndmask_b32 v26, v26, v19, s[56:57]
    v_add_u32 v27, 588, v18
    v_cndmask_b32 v27, v27, v19, s[56:57]
    v_add_u32 v28, 24, v18
    v_cndmask_b32 v28, v28, v19, s[56:57]
    v_cndmask_b32 v28, v28, v20, s[58:59]
    v_add_u32 v29, 600, v18
    v_cndmask_b32 v29, v29, v19, s[56:57]
    v_cndmask_b32 v29, v29, v20, s[58:59]
    v_mul_u32_u24 v21, 3072, v2
    v_and_b32 v22, 15, v0
    v_lshl_add_u32 v21, v22, 2, v21
    s_lshl_b32 s63, s63, 6
    s_add_u32 s63, s63, 32768
    s_add_u32 s61, s63, 12288
    s_lshl_b32 s60, s7, 2
    v_bfe_u32 v30, v0, 2, 2
    v_and_b32 v31, 1, v2
    v_lshl_add_u32 v31, v31, 2, v30
    v_lshlrev_b32 v31, 1, v31
    v_bfe_u32 v70, v0, 1, 1
    v_xor_b32 v31, v31, v70
    v_xor_b32 v31, s60, v31
    v_lshl_add_u32 v30, v2, 3, v30
    v_mul_u32_u24 v30, 256, v30
    v_lshl_add_u32 v30, v31, 4, v30
    v_and_b32 v31, 1, v0
    v_lshl_add_u32 v70, v31, 3, v30
    v_add_u32 v70, 65536, v70
    v_bfe_u32 v30, v0, 2, 2
    v_and_b32 v31, 1, v2
    v_lshl_add_u32 v31, v31, 2, v30
    v_lshlrev_b32 v31, 1, v31
    v_bfe_u32 v71, v0, 1, 1
    v_xor_b32 v31, v31, v71
    v_xor_b32 v31, s60, v31
    v_xor_b32 v31, 2, v31
    v_lshl_add_u32 v30, v2, 3, v30
    v_mul_u32_u24 v30, 256, v30
    v_lshl_add_u32 v30, v31, 4, v30
    v_and_b32 v31, 1, v0
    v_lshl_add_u32 v71, v31, 3, v30
    v_add_u32 v71, 65536, v71
W4_8:
    ds_read_b128 v[32:35], v4 offset:96
    s_sub_u32 s53, s53, 1
    s_cbranch_scc1 L_END
    s_waitcnt lgkmcnt(0)
    v_min3_u32 v32, v32, v33, v34
    v_min_u32 v32, v32, v35
    s_nop 0
    v_readfirstlane_b32 s54, v32
    s_nop 0
    s_cmp_lt_u32 s54, 1
    s_cbranch_scc1 W4_8
    ds_read_b64_tr_b16 v[200:201], v70 offset:0
    ds_read_b64_tr_b16 v[202:203], v70 offset:1024
    ds_read_b64_tr_b16 v[204:205], v70 offset:8192
    ds_read_b64_tr_b16 v[206:207], v70 offset:9216
    ds_read_b64_tr_b16 v[208:209], v70 offset:16384
    ds_read_b64_tr_b16 v[210:211], v70 offset:17408
    ds_read_b64_tr_b16 v[212:213], v70 offset:24576
    ds_read_b64_tr_b16 v[214:215], v70 offset:25600
    s_waitcnt lgkmcnt(0)
    ds_read_b64_tr_b16 v[216:217], v71 offset:0
    ds_read_b64_tr_b16 v[218:219], v71 offset:1024
    ds_read_b64_tr_b16 v[220:221], v71 offset:8192
    ds_read_b64_tr_b16 v[222:223], v71 offset:9216
    ds_read_b64_tr_b16 v[224:225], v71 offset:16384
    ds_read_b64_tr_b16 v[226:227], v71 offset:17408
    ds_read_b64_tr_b16 v[228:229], v71 offset:24576
    ds_read_b64_tr_b16 v[230:231], v71 offset:25600
    s_waitcnt lgkmcnt(0)
    s_barrier
    ds_read_b128 v[64:67], v14 offset:0
    ds_read_b128 v[68:71], v14 offset:64
    ds_read_b128 v[72:75], v14 offset:128
    ds_read_b128 v[76:79], v14 offset:192
    s_waitcnt lgkmcnt(3)
    v_mfma_f32_16x16x32_bf16 v[80:83], v[200:203], v[64:67], 0
    v_mfma_f32_16x16x32_bf16 v[84:87], v[216:219], v[64:67], 0
    s_waitcnt lgkmcnt(2)
    v_mfma_f32_16x16x32_bf16 v[80:83], v[204:207], v[68:71], v[80:83]
    v_mfma_f32_16x16x32_bf16 v[84:87], v[220:223], v[68:71], v[84:87]
    s_waitcnt lgkmcnt(1)
    v_mfma_f32_16x16x32_bf16 v[80:83], v[208:211], v[72:75], v[80:83]
    v_mfma_f32_16x16x32_bf16 v[84:87], v[224:227], v[72:75], v[84:87]
    s_waitcnt lgkmcnt(0)
    v_mfma_f32_16x16x32_bf16 v[80:83], v[212:215], v[76:79], v[80:83]
    v_mfma_f32_16x16x32_bf16 v[84:87], v[228:231], v[76:79], v[84:87]
    s_nop 7
    v_cndmask_b32 v88, v80, v84, s[100:101]
    v_cndmask_b32 v89, v81, v85, s[100:101]
    v_cndmask_b32 v90, v82, v86, s[100:101]
    v_cndmask_b32 v91, v83, v87, s[100:101]
    ds_write_b128 v15, v[88:91]
    ds_read_b32 v92, v24
    ds_read_b32 v93, v25
    ds_read_b32 v94, v26
    ds_read_b32 v95, v27
    ds_read_b32 v96, v28
    ds_read_b32 v97, v29
    s_waitcnt lgkmcnt(5)
    buffer_atomic_add_f32 v92, v21, s[8:11], s63 offen offset:0
    s_waitcnt lgkmcnt(4)
    buffer_atomic_add_f32 v93, v21, s[8:11], s61 offen offset:0
    s_waitcnt lgkmcnt(3)
    buffer_atomic_add_f32 v94, v21, s[8:11], s63 offen offset:1024
    s_waitcnt lgkmcnt(2)
    buffer_atomic_add_f32 v95, v21, s[8:11], s61 offen offset:1024
    s_waitcnt lgkmcnt(1)
    buffer_atomic_add_f32 v96, v21, s[8:11], s63 offen offset:2048
    s_waitcnt lgkmcnt(0)
    buffer_atomic_add_f32 v97, v21, s[8:11], s61 offen offset:2048
    s_cmp_lg_u32 s7, 99
    s_cbranch_scc1 L_V_NOFL
    s_mov_b64 exec, 1
    buffer_store_dword v105, v1, s[8:11], s64 offen sc1
    s_mov_b64 exec, -1
L_V_NOFL:
    s_branch L_FIN
L_K_MAIN:
    s_mov_b32 s12, s66
    s_and_b32 s13, s67, 0xffff
    s_mov_b32 s8, s88
    s_and_b32 s9, s89, 0xffff
    s_mov_b32 s16, s68
    s_and_b32 s17, s69, 0xffff
    s_mov_b32 s18, 67108864
    s_mov_b32 s19, 0x20000
    s_getpc_b64 s[68:69]
L_PCREF:
    s_sub_u32 s68, s68, L_PCREF-L_VW
    s_subb_u32 s69, s69, 0
    s_and_b32 s68, s68, 0xfffffff0
    s_lshr_b32 s60, s2, 3
    s_lshl_b32 s60, s60, 2
    s_add_u32 s60, s60, s3
    s_cmp_ge_u32 s60, (L_END-L_VW)/1024
    s_cbranch_scc1 L_K_NOCP
    s_lshl_b32 s60, s60, 10
    v_add_u32 v14, s60, v12
    global_load_dwordx4 v[20:23], v14, s[68:69]
L_K_NOCP:
    v_and_b32 v15, 3, v0
    v_lshlrev_b32 v120, 8, v15
    v_lshl_add_u32 v120, v2, 4, v120
    v_add_u32 v120, 131072, v120
    v_lshl_add_u32 v121, v15, 4, v4
    s_lshl_b32 s60, s3, 2
    v_add_u32 v122, s60, v121
    v_mul_u32_u24 v14, 528, v15
    v_add_u32 v14, 132096, v14
    v_bfe_u32 v123, v0, 2, 2
    v_lshlrev_b32 v123, 5, v123
    v_lshl_add_u32 v123, v2, 3, v123
    s_lshl_b32 s60, s3, 7
    v_add3_u32 v123, v123, s60, v14
    s_lshl_b32 s60, s4, 2
    v_add_u32 v124, s60, v15
    s_lshr_b32 s60, s2, 3
    v_lshlrev_b32 v124, 5, v124
    v_add_u32 v124, s60, v124
    v_lshlrev_b32 v124, 4, v124
    s_lshl_b32 s60, s3, 8
    s_add_u32 s60, s60, 131072
    v_lshl_add_u32 v125, v0, 2, s60
    s_lshl_b32 s60, s3, 14
    s_add_u32 s60, s60, 65536
    v_xor_b32 v126, 0, v2
    v_xor_b32 v126, v126, v3
    v_lshlrev_b32 v126, 4, v126
    v_lshl_add_u32 v126, v3, 8, v126
    v_add_u32 v126, s60, v126
    v_xor_b32 v127, 4, v2
    v_xor_b32 v127, v127, v3
    v_lshlrev_b32 v127, 4, v127
    v_lshl_add_u32 v127, v3, 8, v127
    v_add_u32 v127, s60, v127
    v_xor_b32 v128, 8, v2
    v_xor_b32 v128, v128, v3
    v_lshlrev_b32 v128, 4, v128
    v_lshl_add_u32 v128, v3, 8, v128
    v_add_u32 v128, s60, v128
    v_xor_b32 v129, 12, v2
    v_xor_b32 v129, v129, v3
    v_lshlrev_b32 v129, 4, v129
    v_lshl_add_u32 v129, v3, 8, v129
    v_add_u32 v129, s60, v129
    s_mov_b32 s94, 0x00f000f0
    s_mov_b32 s95, 0x00f000f0
    s_mov_b32 s96, 0x0f000f00
    s_mov_b32 s97, 0x0f000f00
    s_mov_b32 s98, 0xf000f000
    s_mov_b32 s99, 0xf000f000
    s_lshl_b32 s59, s63, 14
    s_lshl_b32 s60, s3, 10
    s_add_u32 s59, s59, s60
    s_add_u32 s64, s59, 262144
    s_add_u32 s65, s64, 4096
    s_add_u32 s66, s65, 4096
    s_add_u32 s67, s66, 4096
    v_xor_b32 v16, 0, v2
    v_xor_b32 v16, v16, v3
    v_lshlrev_b32 v16, 4, v16
    v_lshl_add_u32 v16, v2, 8, v16
    v_xor_b32 v17, 4, v2
    v_xor_b32 v17, v17, v3
    v_lshlrev_b32 v17, 4, v17
    v_lshl_add_u32 v17, v2, 8, v17
    v_xor_b32 v18, 8, v2
    v_xor_b32 v18, v18, v3
    v_lshlrev_b32 v18, 4, v18
    v_lshl_add_u32 v18, v2, 8, v18
    v_xor_b32 v19, 12, v2
    v_xor_b32 v19, v19, v3
    v_lshlrev_b32 v19, 4, v19
    v_lshl_add_u32 v19, v2, 8, v19
    s_lshl_b32 s60, s3, 14
    s_add_u32 s68, s60, s58
    s_add_u32 m0, s60, 65536
    s_add_u32 s68, s68, 6144
    s_add_u32 m0, m0, 6144
    s_and_b32 s60, s3, 1
    s_lshl_b32 s60, s60, 3
    v_lshlrev_b32 v13, 1, v2
    v_or_b32 v13, s60, v13
    v_xor_b32 v13, v13, v3
    v_lshlrev_b32 v13, 4, v13
    v_lshl_add_u32 v13, v2, 8, v13
    s_lshl_b32 s61, s3, 11
    s_add_u32 s69, s58, s61
    ds_read_b128 v[24:27], v4 offset:544
    s_waitcnt vmcnt(4) lgkmcnt(0)
    v_and_b32 v24, v24, v25
    v_and_b32 v26, v26, v27
    v_and_b32 v24, v24, v26
    s_nop 0
    v_readfirstlane_b32 s54, v24
    s_nop 0
    s_cmp_lg_u32 s54, 0
    s_cbranch_scc1 L_KF6
    buffer_load_dwordx4 v18, s[12:15], s68 offen nt lds
    s_add_u32 m0, m0, 1024
    s_add_u32 s68, s68, 1024
    ds_read_b128 v[24:27], v4 offset:544
    s_waitcnt vmcnt(4) lgkmcnt(0)
    v_and_b32 v24, v24, v25
    v_and_b32 v26, v26, v27
    v_and_b32 v24, v24, v26
    s_nop 0
    v_readfirstlane_b32 s54, v24
    s_nop 0
    s_cmp_lg_u32 s54, 0
    s_cbranch_scc1 L_KF7
    buffer_load_dwordx4 v19, s[12:15], s68 offen nt lds
    s_add_u32 m0, m0, 1024
    s_add_u32 s68, s68, 1024
    ds_read_b128 v[24:27], v4 offset:544
    s_waitcnt vmcnt(4) lgkmcnt(0)
    v_and_b32 v24, v24, v25
    v_and_b32 v26, v26, v27
    v_and_b32 v24, v24, v26
    s_nop 0
    v_readfirstlane_b32 s54, v24
    s_nop 0
    s_cmp_lg_u32 s54, 0
    s_cbranch_scc1 L_KF8
    buffer_load_dwordx4 v16, s[12:15], s68 offen nt lds
    s_add_u32 m0, m0, 1024
    s_add_u32 s68, s68, 1024
    ds_read_b128 v[24:27], v4 offset:544
    s_waitcnt vmcnt(4) lgkmcnt(0)
    v_and_b32 v24, v24, v25
    v_and_b32 v26, v26, v27
    v_and_b32 v24, v24, v26
    s_nop 0
    v_readfirstlane_b32 s54, v24
    s_nop 0
    s_cmp_lg_u32 s54, 0
    s_cbranch_scc1 L_KF9
    buffer_load_dwordx4 v17, s[12:15], s68 offen nt lds
    s_add_u32 m0, m0, 1024
    s_add_u32 s68, s68, 1024
    ds_read_b128 v[24:27], v4 offset:544
    s_waitcnt vmcnt(4) lgkmcnt(0)
    v_and_b32 v24, v24, v25
    v_and_b32 v26, v26, v27
    v_and_b32 v24, v24, v26
    s_nop 0
    v_readfirstlane_b32 s54, v24
    s_nop 0
    s_cmp_lg_u32 s54, 0
    s_cbranch_scc1 L_KF10
    buffer_load_dwordx4 v18, s[12:15], s68 offen nt lds
    s_add_u32 m0, m0, 1024
    s_add_u32 s68, s68, 1024
    ds_read_b128 v[24:27], v4 offset:544
    s_waitcnt vmcnt(4) lgkmcnt(0)
    v_and_b32 v24, v24, v25
    v_and_b32 v26, v26, v27
    v_and_b32 v24, v24, v26
    s_nop 0
    v_readfirstlane_b32 s54, v24
    s_nop 0
    s_cmp_lg_u32 s54, 0
    s_cbranch_scc1 L_KF11
    buffer_load_dwordx4 v19, s[12:15], s68 offen nt lds
    s_add_u32 m0, m0, 1024
    s_add_u32 s68, s68, 1024
    ds_read_b128 v[24:27], v4 offset:544
    s_waitcnt vmcnt(4) lgkmcnt(0)
    v_and_b32 v24, v24, v25
    v_and_b32 v26, v26, v27
    v_and_b32 v24, v24, v26
    s_nop 0
    v_readfirstlane_b32 s54, v24
    s_nop 0
    s_cmp_lg_u32 s54, 0
    s_cbranch_scc1 L_KF12
    buffer_load_dwordx4 v16, s[12:15], s68 offen nt lds
    s_add_u32 m0, m0, 1024
    s_add_u32 s68, s68, 1024
    ds_read_b128 v[24:27], v4 offset:544
    s_waitcnt vmcnt(4) lgkmcnt(0)
    v_and_b32 v24, v24, v25
    v_and_b32 v26, v26, v27
    v_and_b32 v24, v24, v26
    s_nop 0
    v_readfirstlane_b32 s54, v24
    s_nop 0
    s_cmp_lg_u32 s54, 0
    s_cbranch_scc1 L_KF13
    buffer_load_dwordx4 v17, s[12:15], s68 offen nt lds
    s_add_u32 m0, m0, 1024
    s_add_u32 s68, s68, 1024
    ds_read_b128 v[24:27], v4 offset:544
    s_waitcnt vmcnt(4) lgkmcnt(0)
    v_and_b32 v24, v24, v25
    v_and_b32 v26, v26, v27
    v_and_b32 v24, v24, v26
    s_nop 0
    v_readfirstlane_b32 s54, v24
    s_nop 0
    s_cmp_lg_u32 s54, 0
    s_cbranch_scc1 L_KF14
    buffer_load_dwordx4 v18, s[12:15], s68 offen nt lds
    s_add_u32 m0, m0, 1024
    s_add_u32 s68, s68, 1024
    ds_read_b128 v[24:27], v4 offset:544
    s_waitcnt vmcnt(4) lgkmcnt(0)
    v_and_b32 v24, v24, v25
    v_and_b32 v26, v26, v27
    v_and_b32 v24, v24, v26
    s_nop 0
    v_readfirstlane_b32 s54, v24
    s_nop 0
    s_cmp_lg_u32 s54, 0
    s_cbranch_scc1 L_KF15
    buffer_load_dwordx4 v19, s[12:15], s68 offen nt lds
    s_mov_b32 m0, s61
    ds_read_b128 v[24:27], v4 offset:544
    s_waitcnt vmcnt(4) lgkmcnt(0)
    v_and_b32 v24, v24, v25
    v_and_b32 v26, v26, v27
    v_and_b32 v24, v24, v26
    s_nop 0
    v_readfirstlane_b32 s54, v24
    s_nop 0
    s_cmp_lg_u32 s54, 0
    s_cbranch_scc1 L_KF16
    buffer_load_dwordx4 v13, s[16:19], s69 offen nt lds
    s_add_u32 m0, m0, 1024
    s_add_u32 s69, s69, 1024
    ds_read_b128 v[24:27], v4 offset:544
    s_waitcnt vmcnt(4) lgkmcnt(0)
    v_and_b32 v24, v24, v25
    v_and_b32 v26, v26, v27
    v_and_b32 v24, v24, v26
    s_nop 0
    v_readfirstlane_b32 s54, v24
    s_nop 0
    s_cmp_lg_u32 s54, 0
    s_cbranch_scc1 L_KF17
    buffer_load_dwordx4 v13, s[16:19], s69 offen nt lds
    s_add_u32 m0, m0, 7168
    s_add_u32 s69, s69, 7168
    ds_read_b128 v[24:27], v4 offset:544
    s_waitcnt vmcnt(4) lgkmcnt(0)
    v_and_b32 v24, v24, v25
    v_and_b32 v26, v26, v27
    v_and_b32 v24, v24, v26
    s_nop 0
    v_readfirstlane_b32 s54, v24
    s_nop 0
    s_cmp_lg_u32 s54, 0
    s_cbranch_scc1 L_KF18
    buffer_load_dwordx4 v13, s[16:19], s69 offen nt lds
    s_add_u32 m0, m0, 1024
    s_add_u32 s69, s69, 1024
    ds_read_b128 v[24:27], v4 offset:544
    s_waitcnt vmcnt(4) lgkmcnt(0)
    v_and_b32 v24, v24, v25
    v_and_b32 v26, v26, v27
    v_and_b32 v24, v24, v26
    s_nop 0
    v_readfirstlane_b32 s54, v24
    s_nop 0
    s_cmp_lg_u32 s54, 0
    s_cbranch_scc1 L_KF19
    buffer_load_dwordx4 v13, s[16:19], s69 offen nt lds
    s_add_u32 m0, m0, 7168
    s_add_u32 s69, s69, 7168
    ds_read_b128 v[24:27], v4 offset:544
    s_waitcnt vmcnt(4) lgkmcnt(0)
    v_and_b32 v24, v24, v25
    v_and_b32 v26, v26, v27
    v_and_b32 v24, v24, v26
    s_nop 0
    v_readfirstlane_b32 s54, v24
    s_nop 0
    s_cmp_lg_u32 s54, 0
    s_cbranch_scc1 L_KF20
    buffer_load_dwordx4 v13, s[16:19], s69 offen nt lds
    s_add_u32 m0, m0, 1024
    s_add_u32 s69, s69, 1024
    ds_read_b128 v[24:27], v4 offset:544
    s_waitcnt vmcnt(4) lgkmcnt(0)
    v_and_b32 v24, v24, v25
    v_and_b32 v26, v26, v27
    v_and_b32 v24, v24, v26
    s_nop 0
    v_readfirstlane_b32 s54, v24
    s_nop 0
    s_cmp_lg_u32 s54, 0
    s_cbranch_scc1 L_KF21
    buffer_load_dwordx4 v13, s[16:19], s69 offen nt lds
    s_add_u32 m0, m0, 7168
    s_add_u32 s69, s69, 7168
    ds_read_b128 v[24:27], v4 offset:544
    s_waitcnt vmcnt(4) lgkmcnt(0)
    v_and_b32 v24, v24, v25
    v_and_b32 v26, v26, v27
    v_and_b32 v24, v24, v26
    s_nop 0
    v_readfirstlane_b32 s54, v24
    s_nop 0
    s_cmp_lg_u32 s54, 0
    s_cbranch_scc1 L_KF22
    buffer_load_dwordx4 v13, s[16:19], s69 offen nt lds
    s_add_u32 m0, m0, 1024
    s_add_u32 s69, s69, 1024
    ds_read_b128 v[24:27], v4 offset:544
    s_waitcnt vmcnt(4) lgkmcnt(0)
    v_and_b32 v24, v24, v25
    v_and_b32 v26, v26, v27
    v_and_b32 v24, v24, v26
    s_nop 0
    v_readfirstlane_b32 s54, v24
    s_nop 0
    s_cmp_lg_u32 s54, 0
    s_cbranch_scc1 L_KF23
    buffer_load_dwordx4 v13, s[16:19], s69 offen nt lds
    s_add_u32 m0, m0, 7168
    s_add_u32 s69, s69, 7168
    s_branch L_KFE
L_KF6:
    buffer_load_dwordx4 v18, s[12:15], s68 offen nt lds
    s_add_u32 m0, m0, 1024
    s_add_u32 s68, s68, 1024
L_KF7:
    buffer_load_dwordx4 v19, s[12:15], s68 offen nt lds
    s_add_u32 m0, m0, 1024
    s_add_u32 s68, s68, 1024
L_KF8:
    buffer_load_dwordx4 v16, s[12:15], s68 offen nt lds
    s_add_u32 m0, m0, 1024
    s_add_u32 s68, s68, 1024
L_KF9:
    buffer_load_dwordx4 v17, s[12:15], s68 offen nt lds
    s_add_u32 m0, m0, 1024
    s_add_u32 s68, s68, 1024
L_KF10:
    buffer_load_dwordx4 v18, s[12:15], s68 offen nt lds
    s_add_u32 m0, m0, 1024
    s_add_u32 s68, s68, 1024
L_KF11:
    buffer_load_dwordx4 v19, s[12:15], s68 offen nt lds
    s_add_u32 m0, m0, 1024
    s_add_u32 s68, s68, 1024
L_KF12:
    buffer_load_dwordx4 v16, s[12:15], s68 offen nt lds
    s_add_u32 m0, m0, 1024
    s_add_u32 s68, s68, 1024
L_KF13:
    buffer_load_dwordx4 v17, s[12:15], s68 offen nt lds
    s_add_u32 m0, m0, 1024
    s_add_u32 s68, s68, 1024
L_KF14:
    buffer_load_dwordx4 v18, s[12:15], s68 offen nt lds
    s_add_u32 m0, m0, 1024
    s_add_u32 s68, s68, 1024
L_KF15:
    buffer_load_dwordx4 v19, s[12:15], s68 offen nt lds
    s_mov_b32 m0, s61
L_KF16:
    s_nop 0
    buffer_load_dwordx4 v13, s[16:19], s69 offen nt lds
    s_add_u32 m0, m0, 1024
    s_add_u32 s69, s69, 1024
L_KF17:
    buffer_load_dwordx4 v13, s[16:19], s69 offen nt lds
    s_add_u32 m0, m0, 7168
    s_add_u32 s69, s69, 7168
L_KF18:
    buffer_load_dwordx4 v13, s[16:19], s69 offen nt lds
    s_add_u32 m0, m0, 1024
    s_add_u32 s69, s69, 1024
L_KF19:
    buffer_load_dwordx4 v13, s[16:19], s69 offen nt lds
    s_add_u32 m0, m0, 7168
    s_add_u32 s69, s69, 7168
L_KF20:
    buffer_load_dwordx4 v13, s[16:19], s69 offen nt lds
    s_add_u32 m0, m0, 1024
    s_add_u32 s69, s69, 1024
L_KF21:
    buffer_load_dwordx4 v13, s[16:19], s69 offen nt lds
    s_add_u32 m0, m0, 7168
    s_add_u32 s69, s69, 7168
L_KF22:
    buffer_load_dwordx4 v13, s[16:19], s69 offen nt lds
    s_add_u32 m0, m0, 1024
    s_add_u32 s69, s69, 1024
L_KF23:
    buffer_load_dwordx4 v13, s[16:19], s69 offen nt lds
    s_add_u32 m0, m0, 7168
    s_add_u32 s69, s69, 7168
L_KFE:
    ds_write_b32 v7, v5 offset:304
W4_9:
    ds_read_b128 v[56:59], v4 offset:32
    s_sub_u32 s53, s53, 1
    s_cbranch_scc1 L_END
    s_waitcnt lgkmcnt(0)
    v_min3_u32 v56, v56, v57, v58
    v_min_u32 v56, v56, v59
    s_nop 0
    v_readfirstlane_b32 s54, v56
    s_sleep 1
    s_cmp_lt_u32 s54, 2
    s_cbranch_scc1 W4_9
    ds_read_b32 v14, v4 offset:0
    s_setprio 3
    ds_read_b128 v[80:83], v120 offset:0
    ds_read_b128 v[84:87], v120 offset:64
    ds_read_b128 v[88:91], v120 offset:128
    ds_read_b128 v[92:95], v120 offset:192
    s_waitcnt lgkmcnt(4)
    v_readfirstlane_b32 s52, v14
    s_waitcnt vmcnt(20)
    ds_read_b128 v[132:135], v126 offset:0
    ds_read_b128 v[136:139], v127 offset:0
    ds_read_b128 v[140:143], v128 offset:0
    ds_read_b128 v[144:147], v129 offset:0
    s_waitcnt lgkmcnt(3)
    v_mfma_f32_16x16x32_bf16 v[96:99], v[132:135], v[80:83], 0
    s_waitcnt lgkmcnt(2)
    v_mfma_f32_16x16x32_bf16 v[96:99], v[136:139], v[84:87], v[96:99]
    s_waitcnt lgkmcnt(1)
    v_mfma_f32_16x16x32_bf16 v[96:99], v[140:143], v[88:91], v[96:99]
    s_waitcnt lgkmcnt(0)
    v_mfma_f32_16x16x32_bf16 v[96:99], v[144:147], v[92:95], v[96:99]
    s_waitcnt vmcnt(16)
    ds_read_b128 v[148:151], v126 offset:4096
    ds_read_b128 v[152:155], v127 offset:4096
    ds_read_b128 v[156:159], v128 offset:4096
    ds_read_b128 v[160:163], v129 offset:4096
    s_waitcnt lgkmcnt(3)
    v_mfma_f32_16x16x32_bf16 v[100:103], v[148:151], v[80:83], 0
    s_waitcnt lgkmcnt(2)
    v_mfma_f32_16x16x32_bf16 v[100:103], v[152:155], v[84:87], v[100:103]
    s_waitcnt lgkmcnt(1)
    v_mfma_f32_16x16x32_bf16 v[100:103], v[156:159], v[88:91], v[100:103]
    s_waitcnt lgkmcnt(0)
    v_mfma_f32_16x16x32_bf16 v[100:103], v[160:163], v[92:95], v[100:103]
    s_waitcnt vmcnt(12)
    ds_read_b128 v[164:167], v126 offset:8192
    ds_read_b128 v[168:171], v127 offset:8192
    ds_read_b128 v[172:175], v128 offset:8192
    ds_read_b128 v[176:179], v129 offset:8192
    s_waitcnt lgkmcnt(3)
    v_mfma_f32_16x16x32_bf16 v[104:107], v[164:167], v[80:83], 0
    s_waitcnt lgkmcnt(2)
    v_mfma_f32_16x16x32_bf16 v[104:107], v[168:171], v[84:87], v[104:107]
    s_waitcnt lgkmcnt(1)
    v_mfma_f32_16x16x32_bf16 v[104:107], v[172:175], v[88:91], v[104:107]
    s_waitcnt lgkmcnt(0)
    v_mfma_f32_16x16x32_bf16 v[104:107], v[176:179], v[92:95], v[104:107]
    s_waitcnt vmcnt(8)
    ds_read_b128 v[180:183], v126 offset:12288
    ds_read_b128 v[184:187], v127 offset:12288
    ds_read_b128 v[188:191], v128 offset:12288
    ds_read_b128 v[192:195], v129 offset:12288
    s_waitcnt lgkmcnt(3)
    v_mfma_f32_16x16x32_bf16 v[108:111], v[180:183], v[80:83], 0
    s_waitcnt lgkmcnt(2)
    v_mfma_f32_16x16x32_bf16 v[108:111], v[184:187], v[84:87], v[108:111]
    s_waitcnt lgkmcnt(1)
    v_mfma_f32_16x16x32_bf16 v[108:111], v[188:191], v[88:91], v[108:111]
    s_waitcnt lgkmcnt(0)
    v_mfma_f32_16x16x32_bf16 v[108:111], v[192:195], v[92:95], v[108:111]
    v_cndmask_b32 v112, v96, v100, s[94:95]
    v_cndmask_b32 v113, v97, v101, s[94:95]
    v_cndmask_b32 v114, v98, v102, s[94:95]
    v_cndmask_b32 v115, v99, v103, s[94:95]
    v_cndmask_b32 v112, v112, v104, s[96:97]
    v_cndmask_b32 v113, v113, v105, s[96:97]
    v_cndmask_b32 v114, v114, v106, s[96:97]
    v_cndmask_b32 v115, v115, v107, s[96:97]
    v_cndmask_b32 v112, v112, v108, s[98:99]
    v_cndmask_b32 v113, v113, v109, s[98:99]
    v_cndmask_b32 v114, v114, v110, s[98:99]
    v_cndmask_b32 v115, v115, v111, s[98:99]
    v_cvt_pk_bf16_f32 v116, v112, v113
    v_lshlrev_b32 v112, 16, v116
    v_and_b32 v113, 0xffff0000, v116
    v_cvt_pk_bf16_f32 v117, v114, v115
    v_lshlrev_b32 v114, 16, v117
    v_and_b32 v115, 0xffff0000, v117
    s_mov_b32 s55, 1035273459
    v_mul_f32 v112, s55, v112
    v_mul_f32 v113, s55, v113
    v_mul_f32 v114, s55, v114
    v_mul_f32 v115, s55, v115
    v_cvt_pk_bf16_f32 v116, v112, v113
    v_lshlrev_b32 v112, 16, v116
    v_and_b32 v113, 0xffff0000, v116
    v_cvt_pk_bf16_f32 v117, v114, v115
    v_lshlrev_b32 v114, 16, v117
    v_and_b32 v115, 0xffff0000, v117
    v_max_f32 v118, v112, v113
    v_max3_f32 v118, v118, v114, v115
    s_nop 1
    v_max_f32_dpp v118, v118, v118 row_ror:4 row_mask:0xf bank_mask:0xf
    s_nop 1
    v_max_f32_dpp v118, v118, v118 row_ror:8 row_mask:0xf bank_mask:0xf
    v_mov_b32 v119, v118
    s_nop 1
    v_permlane16_swap_b32 v118, v119
    v_max_f32 v118, v118, v119
    v_mov_b32 v119, v118
    s_nop 1
    v_permlane32_swap_b32 v118, v119
    v_max_f32 v118, v118, v119
    ds_write_b32 v122, v118 offset:320
    ds_write_b32 v7, v5 offset:48
W4_10:
    ds_read_b128 v[56:59], v4 offset:48
    s_sub_u32 s53, s53, 1
    s_cbranch_scc1 L_END
    s_waitcnt lgkmcnt(0)
    v_min3_u32 v56, v56, v57, v58
    v_min_u32 v56, v56, v59
    s_nop 0
    v_readfirstlane_b32 s54, v56
    s_nop 0
    s_cmp_lt_u32 s54, 1
    s_cbranch_scc1 W4_10
    ds_read_b128 v[56:59], v121 offset:320
    s_waitcnt lgkmcnt(0)
    v_max3_f32 v118, v56, v57, v58
    v_max_f32 v118, v118, v59
    s_mov_b32 s55, 1069066811
    v_sub_f32 v112, v112, v118
    v_sub_f32 v113, v113, v118
    v_sub_f32 v114, v114, v118
    v_sub_f32 v115, v115, v118
    v_mul_f32 v112, s55, v112
    v_mul_f32 v113, s55, v113
    v_mul_f32 v114, s55, v114
    v_mul_f32 v115, s55, v115
    v_exp_f32 v112, v112
    v_exp_f32 v113, v113
    v_exp_f32 v114, v114
    v_exp_f32 v115, v115
    v_add_f32 v119, v112, v113
    v_add_f32 v56, v114, v115
    v_add_f32 v119, v119, v56
    v_cvt_pk_bf16_f32 v116, v112, v113
    v_cvt_pk_bf16_f32 v117, v114, v115
    ds_write_b64 v123, v[116:117]
    v_add_f32_dpp v119, v119, v119 row_ror:4 row_mask:0xf bank_mask:0xf
    s_nop 1
    v_add_f32_dpp v119, v119, v119 row_ror:8 row_mask:0xf bank_mask:0xf
    v_mov_b32 v56, v119
    s_nop 1
    v_permlane16_swap_b32 v119, v56
    v_add_f32 v119, v119, v56
    v_mov_b32 v56, v119
    s_nop 1
    v_permlane32_swap_b32 v119, v56
    v_add_f32 v119, v119, v56
    ds_write_b32 v122, v119 offset:384
    ds_write_b32 v7, v5 offset:64
W4_11:
    ds_read_b128 v[56:59], v4 offset:64
    s_sub_u32 s53, s53, 1
    s_cbranch_scc1 L_END
    s_waitcnt lgkmcnt(0)
    v_min3_u32 v56, v56, v57, v58
    v_min_u32 v56, v56, v59
    s_nop 0
    v_readfirstlane_b32 s54, v56
    s_nop 0
    s_cmp_lt_u32 s54, 1
    s_cbranch_scc1 W4_11
    ds_read_b128 v[56:59], v121 offset:384
    s_waitcnt lgkmcnt(0)
    v_add_f32 v119, v56, v57
    v_add_f32 v58, v58, v59
    v_add_f32 v58, v119, v58
    v_mov_b32 v56, v118
    v_mov_b32 v57, s52
    v_mov_b32 v59, s52
    s_lshl_b64 s[56:57], 1, s3
    s_mov_b32 s61, 4096
    s_mov_b64 exec, s[56:57]
    buffer_store_dwordx4 v[56:59], v124, s[8:11], s61 offen sc1
    s_mov_b32 s61, 4198400
    buffer_store_dwordx4 v[56:59], v124, s[8:11], s61 offen
    s_mov_b64 exec, -1
    s_setprio 0
    s_cmp_ge_u32 s6, 2
    s_cbranch_scc1 L_K_NOTWO
    s_lshl_b32 s62, s5, 1
    s_add_u32 s62, s62, s6
    s_lshr_b32 s59, s62, 2
    s_and_b32 s60, s62, 3
    s_lshl_b32 s62, s4, 2
    s_add_u32 s60, s60, s62
    s_lshl_b32 s60, s60, 17
    s_lshl_b32 s59, s59, 8
    s_add_u32 s59, s59, s60
    s_lshl_b32 s60, s3, 15
    s_add_u32 s59, s59, s60
    s_lshl_b32 s60, s3, 13
    s_add_u32 m0, s60, 65536
    v_lshlrev_b32 v16, 1, v2
    v_xor_b32 v16, v16, v3
    v_xor_b32 v17, 8, v16
    v_lshlrev_b32 v16, 4, v16
    v_lshlrev_b32 v17, 4, v17
    v_lshl_add_u32 v16, v2, 10, v16
    v_lshl_add_u32 v17, v2, 10, v17
    s_mov_b32 s24, s72
    s_and_b32 s25, s73, 0xffff
    buffer_load_dwordx4 v16, s[24:27], s59 offen nt lds
    s_add_u32 m0, m0, 1024
    s_add_u32 s59, s59, 4096
    buffer_load_dwordx4 v16, s[24:27], s59 offen nt lds
    s_add_u32 m0, m0, 1024
    s_add_u32 s59, s59, 4096
    buffer_load_dwordx4 v17, s[24:27], s59 offen nt lds
    s_add_u32 m0, m0, 1024
    s_add_u32 s59, s59, 4096
    buffer_load_dwordx4 v17, s[24:27], s59 offen nt lds
    s_add_u32 m0, m0, 1024
    s_add_u32 s59, s59, 4096
    buffer_load_dwordx4 v16, s[24:27], s59 offen nt lds
    s_add_u32 m0, m0, 1024
    s_add_u32 s59, s59, 4096
    buffer_load_dwordx4 v16, s[24:27], s59 offen nt lds
    s_add_u32 m0, m0, 1024
    s_add_u32 s59, s59, 4096
    buffer_load_dwordx4 v17, s[24:27], s59 offen nt lds
    s_add_u32 m0, m0, 1024
    s_add_u32 s59, s59, 4096
    buffer_load_dwordx4 v17, s[24:27], s59 offen nt lds
    s_waitcnt vmcnt(10)
    ds_write_b32 v7, v5 offset:560
    s_lshl_b32 s58, s5, 1
    s_add_u32 s58, s58, s6
    s_and_b32 s58, s58, 3
    s_lshl_b32 s60, s4, 2
    s_add_u32 s58, s58, s60
    s_setprio 3
    s_lshl_b32 s65, s58, 9
    s_lshl_b32 s60, s3, 7
    s_add_u32 s65, s65, s60
    s_add_u32 s65, s65, 4096
    s_lshl_b32 s58, s58, 15
    s_lshl_b32 s60, s3, 13
    s_add_u32 s58, s58, s60
    s_add_u32 s58, s58, 1310720
    s_add_u32 s59, s58, 4096
    s_mul_i32 s60, s3, 544
    s_add_u32 s60, s60, 134272
    v_lshl_add_u32 v13, v0, 2, s60
    v_and_b32 v14, 7, v0
    v_lshlrev_b32 v15, 7, v14
    v_lshlrev_b32 v14, 4, v14
    s_lshl_b32 s61, s4, 12
    s_lshl_b32 s60, s3, 10
    s_add_u32 s61, s61, s60
    s_add_u32 s61, s61, 3670016
    s_mov_b32 s62, 0xff
    s_lshl_b32 s75, s5, 1
    s_add_u32 s75, s75, s6
    s_lshl_b32 s75, s75, 3
    s_add_u32 s75, s75, s4
    s_lshl_b32 s75, s75, 7
    s_add_u32 s75, s75, 65536
    v_and_b32 v66, 31, v0
    v_lshlrev_b32 v66, 3, v66
    s_lshl_b32 s64, s4, 8
    s_add_u32 s64, s64, 196608
    buffer_load_dwordx2 v[76:77], v66, s[8:11], s64 offen sc1
    v_and_b32 v64, 7, v0
    v_lshlrev_b32 v64, 7, v64
    s_mov_b32 s60, 1024
ZF_12:
    buffer_load_dword v65, v64, s[8:11], s60 offen sc1
    s_sub_u32 s53, s53, 1
    s_cbranch_scc1 L_END
    s_waitcnt vmcnt(0)
    v_cmp_eq_u32 vcc, s52, v65
    s_nop 0
    s_cmp_eq_u64 vcc, -1
    s_cbranch_scc0 ZF_12
    ds_write_b32 v7, v5 offset:96
    s_getreg_b32 s60, hwreg(HW_REG_XCC_ID, 0, 4)
    v_cmp_eq_u32 vcc, s60, v76
    v_cmp_eq_u32 s[56:57], s52, v77
    s_nop 0
    s_and_b64 vcc, vcc, s[56:57]
    s_cmp_eq_u64 vcc, -1
    s_cbranch_scc0 L_E1
    v_add_u32 v66, 4194304, v12
    v_add_u32 v67, 4194304, v14
    s_mov_b32 s64, 3000
W4_13:
    ds_read_b128 v[60:63], v4 offset:80
    s_sub_u32 s53, s53, 1
    s_cbranch_scc1 L_END
    s_waitcnt lgkmcnt(0)
    v_min3_u32 v60, v60, v61, v62
    v_min_u32 v60, v60, v63
    s_nop 0
    v_readfirstlane_b32 s54, v60
    s_nop 0
    s_cmp_lt_u32 s54, 8
    s_cbranch_scc1 W4_13
    buffer_load_dwordx4 v[68:71], v67, s[8:11], s65 offen sc1
    buffer_load_dwordx4 v[16:19], v66, s[8:11], s58 offen offset:0 sc1
    buffer_load_dwordx4 v[20:23], v66, s[8:11], s58 offen offset:1024 sc1
    buffer_load_dwordx4 v[24:27], v66, s[8:11], s58 offen offset:2048 sc1
    buffer_load_dwordx4 v[28:31], v66, s[8:11], s58 offen offset:3072 sc1
    buffer_load_dwordx4 v[32:35], v66, s[8:11], s59 offen offset:0 sc1
    buffer_load_dwordx4 v[36:39], v66, s[8:11], s59 offen offset:1024 sc1
    buffer_load_dwordx4 v[40:43], v66, s[8:11], s59 offen offset:2048 sc1
    buffer_load_dwordx4 v[44:47], v66, s[8:11], s59 offen offset:3072 sc1
    s_waitcnt vmcnt(8)
    v_max_f32_dpp v72, v68, v68 quad_perm:[1,0,3,2] row_mask:0xf bank_mask:0xf
    s_nop 1
    v_max_f32_dpp v72, v72, v72 quad_perm:[2,3,0,1] row_mask:0xf bank_mask:0xf
    v_sub_f32 v72, v68, v72
    v_mul_f32 v72, 1069066811, v72
    v_exp_f32 v72, v72
    s_nop 0
    v_mul_f32 v73, v72, v70
    s_nop 1
    v_add_f32_dpp v73, v73, v73 quad_perm:[1,0,3,2] row_mask:0xf bank_mask:0xf
    s_nop 1
    v_add_f32_dpp v73, v73, v73 quad_perm:[2,3,0,1] row_mask:0xf bank_mask:0xf
    v_rcp_f32 v74, v73
    s_nop 0
    v_mul_f32 v72, v72, v74
    s_nop 0
    v_readlane_b32 s66, v72, 0
    v_readlane_b32 s67, v72, 1
    v_readlane_b32 s68, v72, 2
    v_readlane_b32 s69, v72, 3
    v_readlane_b32 s70, v72, 4
    v_readlane_b32 s71, v72, 5
    v_readlane_b32 s72, v72, 6
    v_readlane_b32 s73, v72, 7
    s_nop 1
L_F1:
    s_waitcnt vmcnt(0)
    v_bitop3_b32 v60, v17, s52, 0 bitop3:0xbe
    v_bitop3_b32 v61, v19, s52, 0 bitop3:0xbe
    v_bitop3_b32 v60, v21, s52, v60 bitop3:0xbe
    v_bitop3_b32 v61, v23, s52, v61 bitop3:0xbe
    v_bitop3_b32 v60, v25, s52, v60 bitop3:0xbe
    v_bitop3_b32 v61, v27, s52, v61 bitop3:0xbe
    v_bitop3_b32 v60, v29, s52, v60 bitop3:0xbe
    v_bitop3_b32 v61, v31, s52, v61 bitop3:0xbe
    v_bitop3_b32 v60, v33, s52, v60 bitop3:0xbe
    v_bitop3_b32 v61, v35, s52, v61 bitop3:0xbe
    v_bitop3_b32 v60, v37, s52, v60 bitop3:0xbe
    v_bitop3_b32 v61, v39, s52, v61 bitop3:0xbe
    v_bitop3_b32 v60, v41, s52, v60 bitop3:0xbe
    v_bitop3_b32 v61, v43, s52, v61 bitop3:0xbe
    v_bitop3_b32 v60, v45, s52, v60 bitop3:0xbe
    v_bitop3_b32 v61, v47, s52, v61 bitop3:0xbe
    v_bitop3_b32 v60, v69, s52, v60 bitop3:0xbe
    v_bitop3_b32 v61, v71, s52, v61 bitop3:0xbe
    v_or_b32 v60, v60, v61
    v_cmp_ne_u32 vcc, 0, v60
    s_nop 0
    s_cmp_eq_u64 vcc, 0
    s_cbranch_scc1 L_E1_FMA
    s_sleep 1
    v_cmp_eq_u32 vcc, s52, v69
    v_cmp_eq_u32 s[56:57], s52, v71
    s_nop 0
    s_and_b64 vcc, vcc, s[56:57]
    s_cmp_eq_u64 vcc, -1
    s_cbranch_scc1 L_F1_c8
    buffer_load_dwordx4 v[68:71], v67, s[8:11], s65 offen sc1
    s_waitcnt vmcnt(0)
    v_max_f32_dpp v72, v68, v68 quad_perm:[1,0,3,2] row_mask:0xf bank_mask:0xf
    s_nop 1
    v_max_f32_dpp v72, v72, v72 quad_perm:[2,3,0,1] row_mask:0xf bank_mask:0xf
    v_sub_f32 v72, v68, v72
    v_mul_f32 v72, 1069066811, v72
    v_exp_f32 v72, v72
    s_nop 0
    v_mul_f32 v73, v72, v70
    s_nop 1
    v_add_f32_dpp v73, v73, v73 quad_perm:[1,0,3,2] row_mask:0xf bank_mask:0xf
    s_nop 1
    v_add_f32_dpp v73, v73, v73 quad_perm:[2,3,0,1] row_mask:0xf bank_mask:0xf
    v_rcp_f32 v74, v73
    s_nop 0
    v_mul_f32 v72, v72, v74
    s_nop 0
    v_readlane_b32 s66, v72, 0
    v_readlane_b32 s67, v72, 1
    v_readlane_b32 s68, v72, 2
    v_readlane_b32 s69, v72, 3
    v_readlane_b32 s70, v72, 4
    v_readlane_b32 s71, v72, 5
    v_readlane_b32 s72, v72, 6
    v_readlane_b32 s73, v72, 7
    s_nop 1
L_F1_c8:
    v_cmp_eq_u32 vcc, s52, v17
    v_cmp_eq_u32 s[56:57], s52, v19
    s_nop 0
    s_and_b64 vcc, vcc, s[56:57]
    s_cmp_eq_u64 vcc, -1
    s_cbranch_scc1 L_F1_c0
    buffer_load_dwordx4 v[16:19], v66, s[8:11], s58 offen offset:0 sc1
L_F1_c0:
    v_cmp_eq_u32 vcc, s52, v21
    v_cmp_eq_u32 s[56:57], s52, v23
    s_nop 0
    s_and_b64 vcc, vcc, s[56:57]
    s_cmp_eq_u64 vcc, -1
    s_cbranch_scc1 L_F1_c1
    buffer_load_dwordx4 v[20:23], v66, s[8:11], s58 offen offset:1024 sc1
L_F1_c1:
    v_cmp_eq_u32 vcc, s52, v25
    v_cmp_eq_u32 s[56:57], s52, v27
    s_nop 0
    s_and_b64 vcc, vcc, s[56:57]
    s_cmp_eq_u64 vcc, -1
    s_cbranch_scc1 L_F1_c2
    buffer_load_dwordx4 v[24:27], v66, s[8:11], s58 offen offset:2048 sc1
L_F1_c2:
    v_cmp_eq_u32 vcc, s52, v29
    v_cmp_eq_u32 s[56:57], s52, v31
    s_nop 0
    s_and_b64 vcc, vcc, s[56:57]
    s_cmp_eq_u64 vcc, -1
    s_cbranch_scc1 L_F1_c3
    buffer_load_dwordx4 v[28:31], v66, s[8:11], s58 offen offset:3072 sc1
L_F1_c3:
    v_cmp_eq_u32 vcc, s52, v33
    v_cmp_eq_u32 s[56:57], s52, v35
    s_nop 0
    s_and_b64 vcc, vcc, s[56:57]
    s_cmp_eq_u64 vcc, -1
    s_cbranch_scc1 L_F1_c4
    buffer_load_dwordx4 v[32:35], v66, s[8:11], s59 offen offset:0 sc1
L_F1_c4:
    v_cmp_eq_u32 vcc, s52, v37
    v_cmp_eq_u32 s[56:57], s52, v39
    s_nop 0
    s_and_b64 vcc, vcc, s[56:57]
    s_cmp_eq_u64 vcc, -1
    s_cbranch_scc1 L_F1_c5
    buffer_load_dwordx4 v[36:39], v66, s[8:11], s59 offen offset:1024 sc1
L_F1_c5:
    v_cmp_eq_u32 vcc, s52, v41
    v_cmp_eq_u32 s[56:57], s52, v43
    s_nop 0
    s_and_b64 vcc, vcc, s[56:57]
    s_cmp_eq_u64 vcc, -1
    s_cbranch_scc1 L_F1_c6
    buffer_load_dwordx4 v[40:43], v66, s[8:11], s59 offen offset:2048 sc1
L_F1_c6:
    v_cmp_eq_u32 vcc, s52, v45
    v_cmp_eq_u32 s[56:57], s52, v47
    s_nop 0
    s_and_b64 vcc, vcc, s[56:57]
    s_cmp_eq_u64 vcc, -1
    s_cbranch_scc1 L_F1_c7
    buffer_load_dwordx4 v[44:47], v66, s[8:11], s59 offen offset:3072 sc1
L_F1_c7:
    s_sub_u32 s64, s64, 1
    s_cbranch_scc0 L_F1
    s_waitcnt vmcnt(0)
    s_mov_b32 s62, 0xff
L_E1:
    buffer_load_dword v60, v15, s[8:11], s61 offen sc1
    s_sub_u32 s53, s53, 1
    s_cbranch_scc1 L_END
    s_waitcnt vmcnt(0)
    v_cmp_eq_u32 vcc, s52, v60
    s_nop 0
    s_and_b32 s60, vcc_lo, s62
    s_cbranch_scc1 L_E1_GO
    s_sleep 2
    s_branch L_E1
L_E1_GO:
    s_bitcmp1_b32 s60, 0
    s_cbranch_scc0 L_E1_l0
    buffer_load_dwordx4 v[16:19], v12, s[8:11], s58 offen offset:0 sc1
L_E1_l0:
    s_bitcmp1_b32 s60, 1
    s_cbranch_scc0 L_E1_l1
    buffer_load_dwordx4 v[20:23], v12, s[8:11], s58 offen offset:1024 sc1
L_E1_l1:
    s_bitcmp1_b32 s60, 2
    s_cbranch_scc0 L_E1_l2
    buffer_load_dwordx4 v[24:27], v12, s[8:11], s58 offen offset:2048 sc1
L_E1_l2:
    s_bitcmp1_b32 s60, 3
    s_cbranch_scc0 L_E1_l3
    buffer_load_dwordx4 v[28:31], v12, s[8:11], s58 offen offset:3072 sc1
L_E1_l3:
    s_bitcmp1_b32 s60, 4
    s_cbranch_scc0 L_E1_l4
    buffer_load_dwordx4 v[32:35], v12, s[8:11], s59 offen offset:0 sc1
L_E1_l4:
    s_bitcmp1_b32 s60, 5
    s_cbranch_scc0 L_E1_l5
    buffer_load_dwordx4 v[36:39], v12, s[8:11], s59 offen offset:1024 sc1
L_E1_l5:
    s_bitcmp1_b32 s60, 6
    s_cbranch_scc0 L_E1_l6
    buffer_load_dwordx4 v[40:43], v12, s[8:11], s59 offen offset:2048 sc1
L_E1_l6:
    s_bitcmp1_b32 s60, 7
    s_cbranch_scc0 L_E1_l7
    buffer_load_dwordx4 v[44:47], v12, s[8:11], s59 offen offset:3072 sc1
L_E1_l7:
    s_cmp_lg_u32 s60, s62
    s_cbranch_scc1 L_E1_NS
L_E1_ST:
    buffer_load_dwordx4 v[68:71], v14, s[8:11], s65 offen sc1
L_E1_NS:
    s_waitcnt vmcnt(0)
    s_bitcmp1_b32 s60, 0
    s_cbranch_scc0 L_E1_c0
    v_cmp_eq_u32 vcc, s52, v17
    v_cmp_eq_u32 s[56:57], s52, v19
    s_nop 0
    s_and_b64 vcc, vcc, s[56:57]
    s_cmp_eq_u64 vcc, -1
    s_cbranch_scc0 L_E1_c0
    s_bitset0_b32 s62, 0
L_E1_c0:
    s_bitcmp1_b32 s60, 1
    s_cbranch_scc0 L_E1_c1
    v_cmp_eq_u32 vcc, s52, v21
    v_cmp_eq_u32 s[56:57], s52, v23
    s_nop 0
    s_and_b64 vcc, vcc, s[56:57]
    s_cmp_eq_u64 vcc, -1
    s_cbranch_scc0 L_E1_c1
    s_bitset0_b32 s62, 1
L_E1_c1:
    s_bitcmp1_b32 s60, 2
    s_cbranch_scc0 L_E1_c2
    v_cmp_eq_u32 vcc, s52, v25
    v_cmp_eq_u32 s[56:57], s52, v27
    s_nop 0
    s_and_b64 vcc, vcc, s[56:57]
    s_cmp_eq_u64 vcc, -1
    s_cbranch_scc0 L_E1_c2
    s_bitset0_b32 s62, 2
L_E1_c2:
    s_bitcmp1_b32 s60, 3
    s_cbranch_scc0 L_E1_c3
    v_cmp_eq_u32 vcc, s52, v29
    v_cmp_eq_u32 s[56:57], s52, v31
    s_nop 0
    s_and_b64 vcc, vcc, s[56:57]
    s_cmp_eq_u64 vcc, -1
    s_cbranch_scc0 L_E1_c3
    s_bitset0_b32 s62, 3
L_E1_c3:
    s_bitcmp1_b32 s60, 4
    s_cbranch_scc0 L_E1_c4
    v_cmp_eq_u32 vcc, s52, v33
    v_cmp_eq_u32 s[56:57], s52, v35
    s_nop 0
    s_and_b64 vcc, vcc, s[56:57]
    s_cmp_eq_u64 vcc, -1
    s_cbranch_scc0 L_E1_c4
    s_bitset0_b32 s62, 4
L_E1_c4:
    s_bitcmp1_b32 s60, 5
    s_cbranch_scc0 L_E1_c5
    v_cmp_eq_u32 vcc, s52, v37
    v_cmp_eq_u32 s[56:57], s52, v39
    s_nop 0
    s_and_b64 vcc, vcc, s[56:57]
    s_cmp_eq_u64 vcc, -1
    s_cbranch_scc0 L_E1_c5
    s_bitset0_b32 s62, 5
L_E1_c5:
    s_bitcmp1_b32 s60, 6
    s_cbranch_scc0 L_E1_c6
    v_cmp_eq_u32 vcc, s52, v41
    v_cmp_eq_u32 s[56:57], s52, v43
    s_nop 0
    s_and_b64 vcc, vcc, s[56:57]
    s_cmp_eq_u64 vcc, -1
    s_cbranch_scc0 L_E1_c6
    s_bitset0_b32 s62, 6
L_E1_c6:
    s_bitcmp1_b32 s60, 7
    s_cbranch_scc0 L_E1_c7
    v_cmp_eq_u32 vcc, s52, v45
    v_cmp_eq_u32 s[56:57], s52, v47
    s_nop 0
    s_and_b64 vcc, vcc, s[56:57]
    s_cmp_eq_u64 vcc, -1
    s_cbranch_scc0 L_E1_c7
    s_bitset0_b32 s62, 7
L_E1_c7:
    s_cmp_lg_u32 s62, 0
    s_cbranch_scc1 L_E1
    v_cmp_eq_u32 vcc, s52, v69
    v_cmp_eq_u32 s[56:57], s52, v71
    s_nop 0
    s_and_b64 vcc, vcc, s[56:57]
    s_mov_b32 s60, 0
    s_sub_u32 s53, s53, 1
    s_cbranch_scc1 L_END
    s_cmp_eq_u64 vcc, -1
    s_cbranch_scc0 L_E1_ST
    v_max_f32_dpp v72, v68, v68 quad_perm:[1,0,3,2] row_mask:0xf bank_mask:0xf
    s_nop 1
    v_max_f32_dpp v72, v72, v72 quad_perm:[2,3,0,1] row_mask:0xf bank_mask:0xf
    v_sub_f32 v72, v68, v72
    v_mul_f32 v72, 1069066811, v72
    v_exp_f32 v72, v72
    s_nop 0
    v_mul_f32 v73, v72, v70
    s_nop 1
    v_add_f32_dpp v73, v73, v73 quad_perm:[1,0,3,2] row_mask:0xf bank_mask:0xf
    s_nop 1
    v_add_f32_dpp v73, v73, v73 quad_perm:[2,3,0,1] row_mask:0xf bank_mask:0xf
    v_rcp_f32 v74, v73
    s_nop 0
    v_mul_f32 v72, v72, v74
    s_nop 0
    v_readlane_b32 s66, v72, 0
    v_readlane_b32 s67, v72, 1
    v_readlane_b32 s68, v72, 2
    v_readlane_b32 s69, v72, 3
    v_readlane_b32 s70, v72, 4
    v_readlane_b32 s71, v72, 5
    v_readlane_b32 s72, v72, 6
    v_readlane_b32 s73, v72, 7
    s_nop 1
L_E1_FMA:
    v_mul_f32 v56, s66, v16
    v_mul_f32 v57, s66, v18
    v_fmac_f32 v56, s67, v20
    v_fmac_f32 v57, s67, v22
    v_fmac_f32 v56, s68, v24
    v_fmac_f32 v57, s68, v26
    v_fmac_f32 v56, s69, v28
    v_fmac_f32 v57, s69, v30
    v_mul_f32 v58, s70, v32
    v_mul_f32 v59, s70, v34
    v_fmac_f32 v58, s71, v36
    v_fmac_f32 v59, s71, v38
    v_fmac_f32 v58, s72, v40
    v_fmac_f32 v59, s72, v42
    v_fmac_f32 v58, s73, v44
    v_fmac_f32 v59, s73, v46
    v_cvt_pk_bf16_f32 v56, v56, v57
    v_cvt_pk_bf16_f32 v58, v58, v59
    ds_write_b32 v13, v56
    ds_write_b32 v13, v58 offset:272
    s_waitcnt lgkmcnt(0)
    s_barrier
    s_cmp_lg_u32 s3, 3
    s_cbranch_scc1 L_K_NOFL
    s_mov_b64 exec, 1
    buffer_store_dword v17, v1, s[8:11], s75 offen sc1
    s_mov_b64 exec, -1
L_K_NOFL:
    s_branch L_FIN
L_K_NOTWO:
    s_waitcnt vmcnt(2)
    ds_write_b32 v7, v5 offset:560
    s_lshl_b32 s62, s5, 1
    s_add_u32 s62, s62, s6
    s_sub_u32 s62, s62, 2
    s_lshr_b32 s63, s62, 2
    s_lshl_b32 s63, s63, 3
    s_add_u32 s63, s63, s4
    s_and_b32 s62, s62, 3
    s_cmp_ge_u32 s63, 28
    s_cbranch_scc1 L_FIN
L_K_MLP:
    s_mov_b32 s32, s76
    s_and_b32 s33, s77, 0xffff
    s_mov_b32 s34, 1835008
    s_mov_b32 s35, 0x20000
    s_mov_b32 s40, s78
    s_and_b32 s41, s79, 0xffff
    s_mov_b32 s42, 3584
    s_mov_b32 s43, 0x20000
    v_lshrrev_b32 v20, 3, v0
    v_mul_u32_u24 v20, 3584, v20
    v_bfe_u32 v16, v0, 4, 1
    v_lshlrev_b32 v16, 1, v16
    v_and_b32 v21, 7, v0
    v_xor_b32 v16, v16, v21
    v_xor_b32 v21, 4, v16
    v_lshl_add_u32 v21, v21, 4, v20
    v_lshl_add_u32 v20, v16, 4, v20
    s_lshl_b32 s58, s63, 7
    s_lshl_b32 s60, s3, 5
    s_add_u32 s60, s60, s58
    v_lshlrev_b32 v16, 3, v2
    buffer_load_dwordx2 v[14:15], v16, s[40:43], s60 offen
    s_mul_i32 s59, s3, 114688
    s_add_u32 s58, s59, s58
    s_lshl_b32 s61, s3, 12
    s_add_u32 s61, s61, 65536
W4_14:
    ds_read_b128 v[16:19], v4 offset:80
    s_sub_u32 s53, s53, 1
    s_cbranch_scc1 L_END
    s_waitcnt lgkmcnt(0)
    v_min3_u32 v16, v16, v17, v18
    v_min_u32 v16, v16, v19
    s_nop 0
    v_readfirstlane_b32 s54, v16
    s_sleep 2
    s_cmp_lt_u32 s54, 9
    s_cbranch_scc1 W4_14
    s_add_u32 s60, s62, 0
    s_and_b32 s60, s60, 3
    s_mul_i32 s59, s60, 458752
    s_add_u32 s59, s59, s58
    s_lshl_b32 s60, s60, 14
    s_add_u32 m0, s60, s61
    s_nop 0
    buffer_load_dwordx4 v20, s[32:35], s59 offen nt lds
    s_add_u32 m0, m0, 1024
    s_add_u32 s59, s59, 28672
    buffer_load_dwordx4 v21, s[32:35], s59 offen nt lds
    s_add_u32 m0, m0, 1024
    s_add_u32 s59, s59, 28672
    buffer_load_dwordx4 v20, s[32:35], s59 offen nt lds
    s_add_u32 m0, m0, 1024
    s_add_u32 s59, s59, 28672
    buffer_load_dwordx4 v21, s[32:35], s59 offen nt lds
    s_add_u32 s60, s62, 1
    s_and_b32 s60, s60, 3
    s_mul_i32 s59, s60, 458752
    s_add_u32 s59, s59, s58
    s_lshl_b32 s60, s60, 14
    s_add_u32 m0, s60, s61
    s_nop 0
    buffer_load_dwordx4 v20, s[32:35], s59 offen nt lds
    s_add_u32 m0, m0, 1024
    s_add_u32 s59, s59, 28672
    buffer_load_dwordx4 v21, s[32:35], s59 offen nt lds
    s_add_u32 m0, m0, 1024
    s_add_u32 s59, s59, 28672
    buffer_load_dwordx4 v20, s[32:35], s59 offen nt lds
    s_add_u32 m0, m0, 1024
    s_add_u32 s59, s59, 28672
    buffer_load_dwordx4 v21, s[32:35], s59 offen nt lds
    s_add_u32 s60, s62, 2
    s_and_b32 s60, s60, 3
    s_mul_i32 s59, s60, 458752
    s_add_u32 s59, s59, s58
    s_lshl_b32 s60, s60, 14
    s_add_u32 m0, s60, s61
    s_nop 0
    buffer_load_dwordx4 v20, s[32:35], s59 offen nt lds
    s_add_u32 m0, m0, 1024
    s_add_u32 s59, s59, 28672
    buffer_load_dwordx4 v21, s[32:35], s59 offen nt lds
    s_add_u32 m0, m0, 1024
    s_add_u32 s59, s59, 28672
    buffer_load_dwordx4 v20, s[32:35], s59 offen nt lds
    s_add_u32 m0, m0, 1024
    s_add_u32 s59, s59, 28672
    buffer_load_dwordx4 v21, s[32:35], s59 offen nt lds
    s_add_u32 s60, s62, 3
    s_and_b32 s60, s60, 3
    s_mul_i32 s59, s60, 458752
    s_add_u32 s59, s59, s58
    s_lshl_b32 s60, s60, 14
    s_add_u32 m0, s60, s61
    s_nop 0
    buffer_load_dwordx4 v20, s[32:35], s59 offen nt lds
    s_add_u32 m0, m0, 1024
    s_add_u32 s59, s59, 28672
    buffer_load_dwordx4 v21, s[32:35], s59 offen nt lds
    s_add_u32 m0, m0, 1024
    s_add_u32 s59, s59, 28672
    buffer_load_dwordx4 v20, s[32:35], s59 offen nt lds
    s_add_u32 m0, m0, 1024
    s_add_u32 s59, s59, 28672
    buffer_load_dwordx4 v21, s[32:35], s59 offen nt lds
    v_and_b32 v16, 1, v0
    v_mul_u32_u24 v232, 1040, v16
    v_lshl_add_u32 v232, v2, 4, v232
    v_add_u32 v232, 148096, v232
    v_mul_u32_u24 v233, 144, v16
    v_lshl_add_u32 v233, v2, 3, v233
    s_lshl_b32 s60, s3, 5
    s_add_u32 s60, s60, 136448
    v_add_u32 v233, s60, v233
    v_lshlrev_b32 v236, 4, v16
    v_add_u32 v236, 147632, v236
    s_mov_b32 s67, 0xbdd2d3e8
    v_mov_b32 v237, 0xc0135761
    s_lshl_b32 s60, s3, 1
    v_bfe_u32 v16, v0, 2, 2
    v_lshrrev_b32 v17, 1, v16
    v_and_b32 v13, 1, v2
    v_lshl_add_u32 v17, v13, 1, v17
    v_lshlrev_b32 v17, 1, v17
    v_bfe_u32 v13, v0, 1, 1
    v_xor_b32 v17, v17, v13
    v_xor_b32 v17, s60, v17
    v_lshl_add_u32 v16, v2, 3, v16
    v_mul_u32_u24 v16, 128, v16
    v_lshl_add_u32 v16, v17, 4, v16
    v_and_b32 v17, 1, v0
    v_lshl_add_u32 v13, v17, 3, v16
    v_add_u32 v13, 65536, v13
    s_mul_i32 s60, s3, 8
    v_bfe_u32 v16, v0, 2, 2
    v_and_b32 v17, 1, v2
    v_lshl_add_u32 v17, v17, 2, v16
    v_lshlrev_b32 v17, 1, v17
    v_bfe_u32 v20, v0, 1, 1
    v_xor_b32 v17, v17, v20
    v_xor_b32 v17, s60, v17
    v_lshl_add_u32 v16, v2, 3, v16
    v_mul_u32_u24 v16, 1024, v16
    v_lshl_add_u32 v16, v17, 4, v16
    v_and_b32 v17, 1, v0
    v_lshl_add_u32 v20, v17, 3, v16
    v_bfe_u32 v16, v0, 2, 2
    v_and_b32 v17, 1, v2
    v_lshl_add_u32 v17, v17, 2, v16
    v_lshlrev_b32 v17, 1, v17
    v_bfe_u32 v21, v0, 1, 1
    v_xor_b32 v17, v17, v21
    v_xor_b32 v17, s60, v17
    v_xor_b32 v17, 2, v17
    v_lshl_add_u32 v16, v2, 3, v16
    v_mul_u32_u24 v16, 1024, v16
    v_lshl_add_u32 v16, v17, 4, v16
    v_and_b32 v17, 1, v0
    v_lshl_add_u32 v21, v17, 3, v16
    v_bfe_u32 v16, v0, 2, 2
    v_and_b32 v17, 1, v2
    v_lshl_add_u32 v17, v17, 2, v16
    v_lshlrev_b32 v17, 1, v17
    v_bfe_u32 v22, v0, 1, 1
    v_xor_b32 v17, v17, v22
    v_xor_b32 v17, s60, v17
    v_xor_b32 v17, 4, v17
    v_lshl_add_u32 v16, v2, 3, v16
    v_mul_u32_u24 v16, 1024, v16
    v_lshl_add_u32 v16, v17, 4, v16
    v_and_b32 v17, 1, v0
    v_lshl_add_u32 v22, v17, 3, v16
    v_bfe_u32 v16, v0, 2, 2
    v_and_b32 v17, 1, v2
    v_lshl_add_u32 v17, v17, 2, v16
    v_lshlrev_b32 v17, 1, v17
    v_bfe_u32 v23, v0, 1, 1
    v_xor_b32 v17, v17, v23
    v_xor_b32 v17, s60, v17
    v_xor_b32 v17, 6, v17
    v_lshl_add_u32 v16, v2, 3, v16
    v_mul_u32_u24 v16, 1024, v16
    v_lshl_add_u32 v16, v17, 4, v16
    v_and_b32 v17, 1, v0
    v_lshl_add_u32 v23, v17, 3, v16
    v_and_b32 v16, 1, v0
    v_mul_u32_u24 v234, 144, v16
    v_lshl_add_u32 v234, v2, 4, v234
    v_add_u32 v234, 136448, v234
    s_mov_b32 s94, 0xcccccccc
    s_mov_b32 s95, 0xcccccccc
    s_mov_b32 s96, 0xf0f0f0f0
    s_mov_b32 s97, 0xf0f0f0f0
    s_mov_b32 s98, 0xff00ff00
    s_mov_b32 s99, 0xff00ff00
    v_mov_b32 v161, s52
    s_mov_b32 s44, s82
    s_and_b32 s45, s83, 0xffff
    s_mov_b32 s46, 1024
    s_mov_b32 s47, 0x20000
    s_mov_b32 s48, s84
    s_and_b32 s49, s85, 0xffff
    s_mov_b32 s50, 8192
    s_mov_b32 s51, 0x20000
    s_mul_i32 s60, s3, 544
    s_add_u32 s60, s60, 137600
    v_and_b32 v16, 1, v0
    v_mul_u32_u24 v52, 272, v16
    v_bfe_u32 v17, v0, 1, 2
    v_lshl_add_u32 v52, v17, 6, v52
    v_lshl_add_u32 v52, v2, 4, v52
    v_add_u32 v52, s60, v52
    v_lshrrev_b32 v16, 5, v0
    v_bfe_u32 v17, v0, 2, 3
    v_and_b32 v18, 3, v0
    v_lshl_add_u32 v17, v17, 3, v18
    v_mul_u32_u24 v19, 272, v16
    v_lshl_add_u32 v19, v17, 2, v19
    v_add_u32 v19, s60, v19
    v_mov_b32 v56, 147616
    v_mov_b32 v57, 147620
    v_cmp_eq_u32 s[68:69], 3, v18
    v_cmp_eq_u32 s[70:71], 2, v18
    v_add_u32 v53, 0, v19
    v_cndmask_b32 v53, v53, v56, s[68:69]
    v_add_u32 v54, 12, v19
    v_cndmask_b32 v54, v54, v56, s[68:69]
    v_add_u32 v55, 24, v19
    v_cndmask_b32 v55, v55, v56, s[68:69]
    v_cndmask_b32 v55, v55, v57, s[70:71]
    s_not_b64 s[68:69], s[68:69]
    s_andn2_b64 s[70:71], s[68:69], s[70:71]
    s_and_b32 s60, s62, 0
    s_mul_i32 s60, s60, 1024
    s_mul_i32 s72, s3, 128
    s_add_u32 s60, s60, s72
    v_mul_u32_u24 v56, 3072, v16
    v_and_b32 v57, 31, v0
    v_lshl_add_u32 v56, v57, 2, v56
    s_lshr_b32 s72, s62, 0
    s_mul_i32 s64, s72, 6144
    s_add_u32 s64, s64, s60
    s_add_u32 s64, s64, 229376
    v_lshl_add_u32 v57, v17, 1, s60
    v_lshl_add_u32 v58, v16, 10, v57
    v_mul_u32_u24 v59, 1040, v16
    v_add3_u32 v59, v59, v57, v4
    s_lshl_b32 s72, s72, 11
    buffer_load_ushort v60, v57, s[44:47], 0 offen offset:0
    buffer_load_ushort v61, v57, s[44:47], 0 offen offset:6
    buffer_load_ushort v62, v57, s[44:47], 0 offen offset:12
W4_15:
    ds_read_b128 v[16:19], v4 offset:144
    s_sub_u32 s53, s53, 1
    s_cbranch_scc1 L_END
    s_waitcnt lgkmcnt(0)
    v_min3_u32 v16, v16, v17, v18
    v_min_u32 v16, v16, v19
    s_nop 0
    v_readfirstlane_b32 s54, v16
    s_sleep 1
    s_cmp_lt_u32 s54, 1
    s_cbranch_scc1 W4_15
    ds_read_b64_tr_b16 v[128:129], v20 offset:0
    ds_read_b64_tr_b16 v[130:131], v20 offset:4096
    ds_read_b64_tr_b16 v[132:133], v20 offset:32768
    ds_read_b64_tr_b16 v[134:135], v20 offset:36864
    ds_read_b64_tr_b16 v[136:137], v21 offset:0
    ds_read_b64_tr_b16 v[138:139], v21 offset:4096
    ds_read_b64_tr_b16 v[140:141], v21 offset:32768
    ds_read_b64_tr_b16 v[142:143], v21 offset:36864
    s_waitcnt lgkmcnt(0)
    ds_read_b64_tr_b16 v[144:145], v22 offset:0
    ds_read_b64_tr_b16 v[146:147], v22 offset:4096
    ds_read_b64_tr_b16 v[148:149], v22 offset:32768
    ds_read_b64_tr_b16 v[150:151], v22 offset:36864
    ds_read_b64_tr_b16 v[152:153], v23 offset:0
    ds_read_b64_tr_b16 v[154:155], v23 offset:4096
    ds_read_b64_tr_b16 v[156:157], v23 offset:32768
    ds_read_b64_tr_b16 v[158:159], v23 offset:36864
    s_waitcnt lgkmcnt(0)
    v_mov_b32 v16, 2
    v_mov_b32 v24, 0x3f803f80
    v_mov_b32 v25, 0x3f803f80
    v_mov_b32 v26, 0x3f803f80
    v_mov_b32 v27, 0x3f803f80
    s_waitcnt vmcnt(0)
    ds_write_b32 v7, v16 offset:96
    v_lshlrev_b32 v192, 16, v14
    v_and_b32 v193, 0xffff0000, v14
    v_lshlrev_b32 v194, 16, v15
    v_and_b32 v195, 0xffff0000, v15
W4_16:
    ds_read_b128 v[16:19], v4 offset:96
    s_sub_u32 s53, s53, 1
    s_cbranch_scc1 L_END
    s_waitcnt lgkmcnt(0)
    v_min3_u32 v16, v16, v17, v18
    v_min_u32 v16, v16, v19
    s_nop 0
    v_readfirstlane_b32 s54, v16
    s_nop 0
    s_cmp_lt_u32 s54, 2
    s_cbranch_scc1 W4_16
    ds_read_b64_tr_b16 v[64:65], v13 offset:0
    ds_read_b64_tr_b16 v[66:67], v13 offset:512
    ds_read_b64_tr_b16 v[68:69], v13 offset:4096
    ds_read_b64_tr_b16 v[70:71], v13 offset:4608
    ds_read_b64_tr_b16 v[72:73], v13 offset:8192
    ds_read_b64_tr_b16 v[74:75], v13 offset:8704
    ds_read_b64_tr_b16 v[76:77], v13 offset:12288
    ds_read_b64_tr_b16 v[78:79], v13 offset:12800
    ds_read_b64_tr_b16 v[80:81], v13 offset:16384
    ds_read_b64_tr_b16 v[82:83], v13 offset:16896
    ds_read_b64_tr_b16 v[84:85], v13 offset:20480
    ds_read_b64_tr_b16 v[86:87], v13 offset:20992
    ds_read_b64_tr_b16 v[88:89], v13 offset:24576
    ds_read_b64_tr_b16 v[90:91], v13 offset:25088
    s_waitcnt lgkmcnt(12)
    v_mfma_f32_16x16x32_bf16 v[196:199], v[64:67], v[24:27], 0
    ds_read_b64_tr_b16 v[92:93], v13 offset:28672
    ds_read_b64_tr_b16 v[94:95], v13 offset:29184
    s_waitcnt lgkmcnt(12)
    v_mfma_f32_16x16x32_bf16 v[196:199], v[68:71], v[24:27], v[196:199]
    ds_read_b64_tr_b16 v[96:97], v13 offset:32768
    ds_read_b64_tr_b16 v[98:99], v13 offset:33280
    s_waitcnt lgkmcnt(12)
    v_mfma_f32_16x16x32_bf16 v[196:199], v[72:75], v[24:27], v[196:199]
    ds_read_b64_tr_b16 v[100:101], v13 offset:36864
    ds_read_b64_tr_b16 v[102:103], v13 offset:37376
    s_waitcnt lgkmcnt(12)
    v_mfma_f32_16x16x32_bf16 v[196:199], v[76:79], v[24:27], v[196:199]
    ds_read_b64_tr_b16 v[104:105], v13 offset:40960
    ds_read_b64_tr_b16 v[106:107], v13 offset:41472
    s_waitcnt lgkmcnt(12)
    v_mfma_f32_16x16x32_bf16 v[196:199], v[80:83], v[24:27], v[196:199]
    ds_read_b64_tr_b16 v[108:109], v13 offset:45056
    ds_read_b64_tr_b16 v[110:111], v13 offset:45568
    s_waitcnt lgkmcnt(12)
    v_mfma_f32_16x16x32_bf16 v[196:199], v[84:87], v[24:27], v[196:199]
    ds_read_b64_tr_b16 v[112:113], v13 offset:49152
    ds_read_b64_tr_b16 v[114:115], v13 offset:49664
    s_waitcnt lgkmcnt(12)
    v_mfma_f32_16x16x32_bf16 v[196:199], v[88:91], v[24:27], v[196:199]
    ds_read_b64_tr_b16 v[116:117], v13 offset:53248
    ds_read_b64_tr_b16 v[118:119], v13 offset:53760
    s_waitcnt lgkmcnt(12)
    v_mfma_f32_16x16x32_bf16 v[196:199], v[92:95], v[24:27], v[196:199]
    ds_read_b64_tr_b16 v[120:121], v13 offset:57344
    ds_read_b64_tr_b16 v[122:123], v13 offset:57856
    s_waitcnt lgkmcnt(12)
    v_mfma_f32_16x16x32_bf16 v[196:199], v[96:99], v[24:27], v[196:199]
    ds_read_b64_tr_b16 v[124:125], v13 offset:61440
    ds_read_b64_tr_b16 v[126:127], v13 offset:61952
    s_waitcnt lgkmcnt(12)
    v_mfma_f32_16x16x32_bf16 v[196:199], v[100:103], v[24:27], v[196:199]
    s_waitcnt lgkmcnt(10)
    v_mfma_f32_16x16x32_bf16 v[196:199], v[104:107], v[24:27], v[196:199]
    s_waitcnt lgkmcnt(8)
    v_mfma_f32_16x16x32_bf16 v[196:199], v[108:111], v[24:27], v[196:199]
    s_waitcnt lgkmcnt(6)
    v_mfma_f32_16x16x32_bf16 v[196:199], v[112:115], v[24:27], v[196:199]
    s_waitcnt lgkmcnt(4)
    v_mfma_f32_16x16x32_bf16 v[196:199], v[116:119], v[24:27], v[196:199]
    s_waitcnt lgkmcnt(2)
    v_mfma_f32_16x16x32_bf16 v[196:199], v[120:123], v[24:27], v[196:199]
    s_waitcnt lgkmcnt(0)
    v_mfma_f32_16x16x32_bf16 v[196:199], v[124:127], v[24:27], v[196:199]
    v_cndmask_b32 v29, v192, v193, s[94:95]
    v_cndmask_b32 v30, v194, v195, s[94:95]
    v_cndmask_b32 v192, v29, v30, s[96:97]
    s_nop 4
    v_cndmask_b32 v29, v196, v197, s[94:95]
    v_cndmask_b32 v30, v198, v199, s[94:95]
    v_cndmask_b32 v196, v29, v30, s[96:97]
    v_bfe_u32 v29, v0, 1, 2
    v_lshl_add_u32 v233, v29, 1, v233
    s_setprio 2
    s_barrier
    ds_read_b128 v[200:203], v232 offset:0
    ds_read_b128 v[204:207], v232 offset:64
    ds_read_b128 v[208:211], v232 offset:128
    ds_read_b128 v[212:215], v232 offset:192
    ds_read_b128 v[216:219], v232 offset:256
    ds_read_b128 v[220:223], v232 offset:320
    ds_read_b128 v[224:227], v232 offset:384
    ds_read_b128 v[228:231], v232 offset:448
    ds_read_b128 v[164:167], v232 offset:512
    ds_read_b128 v[168:171], v232 offset:576
    ds_read_b128 v[172:175], v232 offset:640
    ds_read_b128 v[176:179], v232 offset:704
    ds_read_b128 v[180:183], v232 offset:768
    ds_read_b128 v[184:187], v232 offset:832
    ds_read_b128 v[188:191], v232 offset:896
    s_waitcnt lgkmcnt(14)
    v_mfma_f32_16x16x32_bf16 v[16:19], v[64:67], v[200:203], 0
    ds_read_b128 v[24:27], v232 offset:960
    s_waitcnt lgkmcnt(14)
    v_mfma_f32_16x16x32_bf16 v[16:19], v[68:71], v[204:207], v[16:19]
    s_waitcnt lgkmcnt(13)
    v_mfma_f32_16x16x32_bf16 v[16:19], v[72:75], v[208:211], v[16:19]
    s_waitcnt lgkmcnt(12)
    v_mfma_f32_16x16x32_bf16 v[16:19], v[76:79], v[212:215], v[16:19]
    s_waitcnt lgkmcnt(11)
    v_mfma_f32_16x16x32_bf16 v[16:19], v[80:83], v[216:219], v[16:19]
    s_waitcnt lgkmcnt(10)
    v_mfma_f32_16x16x32_bf16 v[16:19], v[84:87], v[220:223], v[16:19]
    s_waitcnt lgkmcnt(9)
    v_mfma_f32_16x16x32_bf16 v[16:19], v[88:91], v[224:227], v[16:19]
    s_waitcnt lgkmcnt(8)
    v_mfma_f32_16x16x32_bf16 v[16:19], v[92:95], v[228:231], v[16:19]
    s_waitcnt lgkmcnt(7)
    v_mfma_f32_16x16x32_bf16 v[16:19], v[96:99], v[164:167], v[16:19]
    s_waitcnt lgkmcnt(6)
    v_mfma_f32_16x16x32_bf16 v[16:19], v[100:103], v[168:171], v[16:19]
    s_waitcnt lgkmcnt(5)
    v_mfma_f32_16x16x32_bf16 v[16:19], v[104:107], v[172:175], v[16:19]
    s_waitcnt lgkmcnt(4)
    v_mfma_f32_16x16x32_bf16 v[16:19], v[108:111], v[176:179], v[16:19]
    s_waitcnt lgkmcnt(3)
    v_mfma_f32_16x16x32_bf16 v[16:19], v[112:115], v[180:183], v[16:19]
    s_waitcnt lgkmcnt(2)
    v_mfma_f32_16x16x32_bf16 v[16:19], v[116:119], v[184:187], v[16:19]
    s_waitcnt lgkmcnt(1)
    v_mfma_f32_16x16x32_bf16 v[16:19], v[120:123], v[188:191], v[16:19]
    s_waitcnt lgkmcnt(0)
    v_mfma_f32_16x16x32_bf16 v[16:19], v[124:127], v[24:27], v[16:19]
    ds_read_b96 v[20:22], v236
    s_nop 6
    v_cndmask_b32 v29, v16, v17, s[94:95]
    v_cndmask_b32 v30, v18, v19, s[94:95]
    v_cndmask_b32 v28, v29, v30, s[96:97]
    s_waitcnt lgkmcnt(0)
    v_cmp_eq_u32 vcc, 1, v22
    s_nop 0
    s_cmp_eq_u64 vcc, -1
    s_cbranch_scc1 L_AB_OK
AB_17:
    ds_read_b96 v[20:22], v236
    s_sub_u32 s53, s53, 1
    s_cbranch_scc1 L_END
    s_waitcnt lgkmcnt(0)
    v_cmp_eq_u32 vcc, 1, v22
    s_nop 0
    s_cmp_eq_u64 vcc, -1
    s_cbranch_scc0 AB_17
L_AB_OK:
    v_mul_f32 v16, v20, v28
    v_fmac_f32 v16, v21, v196
    v_cvt_pk_bf16_f32 v20, v16, v16
    v_lshlrev_b32 v16, 16, v20
    v_add_f32 v16, v16, v192
    v_cvt_pk_bf16_f32 v20, v16, v16
    v_lshlrev_b32 v16, 16, v20
    v_mul_f32 v20, v16, v16
    v_fma_f32 v20, v20, s67, v237
    v_mul_f32 v20, v20, v16
    v_exp_f32 v20, v20
    s_nop 0
    v_add_f32 v20, 1.0, v20
    v_rcp_f32 v20, v20
    s_nop 0
    v_mul_f32 v16, v16, v20
    v_cvt_pk_bf16_f32 v16, v16, v16
    ds_write_b16 v233, v16
    s_waitcnt lgkmcnt(0)
    s_branch L_MLP_W2
L_MLP_W2B:
    s_barrier
L_MLP_W2:
    s_barrier
    ds_read_b128 v[16:19], v234
    ds_read_b128 v[20:23], v234 offset:64
    s_waitcnt lgkmcnt(1)
    v_mfma_f32_16x16x32_bf16 v[24:27], v[128:131], v[16:19], 0
    v_mfma_f32_16x16x32_bf16 v[28:31], v[136:139], v[16:19], 0
    v_mfma_f32_16x16x32_bf16 v[32:35], v[144:147], v[16:19], 0
    v_mfma_f32_16x16x32_bf16 v[36:39], v[152:155], v[16:19], 0
    s_waitcnt lgkmcnt(0)
    v_mfma_f32_16x16x32_bf16 v[24:27], v[132:135], v[20:23], v[24:27]
    v_mfma_f32_16x16x32_bf16 v[28:31], v[140:143], v[20:23], v[28:31]
    v_mfma_f32_16x16x32_bf16 v[32:35], v[148:151], v[20:23], v[32:35]
    v_mfma_f32_16x16x32_bf16 v[36:39], v[156:159], v[20:23], v[36:39]
    s_nop 5
    v_cndmask_b32 v40, v24, v28, s[94:95]
    s_nop 0
    v_cndmask_b32 v44, v32, v36, s[94:95]
    v_cndmask_b32 v41, v25, v29, s[94:95]
    v_cndmask_b32 v45, v33, v37, s[94:95]
    v_cndmask_b32 v42, v26, v30, s[94:95]
    v_cndmask_b32 v46, v34, v38, s[94:95]
    v_cndmask_b32 v43, v27, v31, s[94:95]
    v_cndmask_b32 v47, v35, v39, s[94:95]
    v_cndmask_b32 v40, v40, v44, s[96:97]
    v_cndmask_b32 v41, v41, v45, s[96:97]
    v_cndmask_b32 v42, v42, v46, s[96:97]
    v_cndmask_b32 v43, v43, v47, s[96:97]
    ds_write_b128 v52, v[40:43]
    ds_read_b32 v44, v53
    ds_read_b32 v45, v54
    ds_read_b32 v46, v55
    s_waitcnt lgkmcnt(2)
    v_mov_b32 v48, v44
    buffer_atomic_add_f32 v48, v56, s[8:11], s64 offen offset:0 sc0
    s_waitcnt lgkmcnt(1)
    v_mov_b32 v49, v45
    buffer_atomic_add_f32 v49, v56, s[8:11], s64 offen offset:1024 sc0
    s_waitcnt lgkmcnt(0)
    v_mov_b32 v50, v46
    buffer_atomic_add_f32 v50, v56, s[8:11], s64 offen offset:2048 sc0
    ds_read_u16 v40, v59 offset:640
    ds_read_u16 v41, v59 offset:646
    ds_read_u16 v42, v59 offset:652
    s_waitcnt vmcnt(3)
    v_lshlrev_b32 v60, 16, v60
    v_lshlrev_b32 v61, 16, v61
    v_lshlrev_b32 v62, 16, v62
    s_mov_b32 s60, 0x41d80000
    s_waitcnt lgkmcnt(0)
    v_lshlrev_b32 v40, 16, v40
    v_lshlrev_b32 v41, 16, v41
    v_lshlrev_b32 v42, 16, v42
    s_waitcnt vmcnt(2)
    v_mov_b32_dpp v24, v48 quad_perm:[3,3,3,3] row_mask:0xf bank_mask:0xf
    v_add_f32 v48, v48, v44
    v_cmp_eq_f32 vcc, s60, v24
    v_cvt_pk_bf16_f32 v25, v48, v48
    v_lshlrev_b32 v48, 16, v25
    v_add_f32 v48, v48, v60
    v_cvt_pk_bf16_f32 v25, v48, v48
    v_lshlrev_b32 v48, 16, v25
    v_add_f32 v48, v48, v40
    v_cvt_pk_bf16_f32 v48, v48, v48
    s_and_b64 vcc, vcc, s[68:69]
    v_cndmask_b32 v26, v238, v58, vcc
    buffer_store_short v48, v26, s[48:51], s72 offen offset:0
    s_waitcnt vmcnt(2)
    v_mov_b32_dpp v24, v49 quad_perm:[3,3,3,3] row_mask:0xf bank_mask:0xf
    v_add_f32 v49, v49, v45
    v_cmp_eq_f32 vcc, s60, v24
    v_cvt_pk_bf16_f32 v25, v49, v49
    v_lshlrev_b32 v49, 16, v25
    v_add_f32 v49, v49, v61
    v_cvt_pk_bf16_f32 v25, v49, v49
    v_lshlrev_b32 v49, 16, v25
    v_add_f32 v49, v49, v41
    v_cvt_pk_bf16_f32 v49, v49, v49
    s_and_b64 vcc, vcc, s[68:69]
    v_cndmask_b32 v27, v238, v58, vcc
    buffer_store_short v49, v27, s[48:51], s72 offen offset:6
    s_waitcnt vmcnt(2)
    v_mov_b32_dpp v24, v50 quad_perm:[3,3,3,3] row_mask:0xf bank_mask:0xf
    v_add_f32 v50, v50, v46
    v_cmp_eq_f32 vcc, s60, v24
    v_cvt_pk_bf16_f32 v25, v50, v50
    v_lshlrev_b32 v50, 16, v25
    v_add_f32 v50, v50, v62
    v_cvt_pk_bf16_f32 v25, v50, v50
    v_lshlrev_b32 v50, 16, v25
    v_add_f32 v50, v50, v42
    v_cvt_pk_bf16_f32 v50, v50, v50
    s_and_b64 vcc, vcc, s[70:71]
    v_cndmask_b32 v28, v238, v58, vcc
    buffer_store_short v50, v28, s[48:51], s72 offen offset:12
    s_cmp_lg_u32 s2, 16
    s_cbranch_scc1 L_FIN
    s_cmp_lg_u32 s3, 0
    s_cbranch_scc1 L_FIN
    s_mov_b64 exec, 1
    buffer_store_dword v161, v1, s[8:11], 0 offen sc1
    s_mov_b64 exec, -1
    s_branch L_FIN
L_V_NOTWO:
    ds_write_b32 v7, v14 offset:80
    s_lshl_b32 s62, s5, 1
    s_add_u32 s62, s62, s6
    s_sub_u32 s62, s62, 2
    s_lshr_b32 s63, s62, 2
    s_lshl_b32 s63, s63, 3
    s_add_u32 s63, s63, s4
    s_and_b32 s62, s62, 3
    s_cmp_ge_u32 s63, 28
    s_cbranch_scc1 L_FIN
L_V_MLP:
    s_mov_b32 s36, s80
    s_and_b32 s37, s81, 0xffff
    s_mov_b32 s38, 1835008
    s_mov_b32 s39, 0x20000
    s_lshr_b32 s60, s62, 0
    s_lshl_b32 s60, s60, 1
    s_add_u32 s66, s60, s7
    s_and_b32 s66, s66, 7
    s_lshl_b32 s60, s66, 10
    buffer_load_dwordx4 v[8:11], v12, s[20:23], s60 offen
    s_lshl_b32 s58, s63, 16
    s_lshl_b32 s61, s7, 12
    s_add_u32 s58, s58, s61
    s_lshr_b32 s60, s7, 1
    s_lshl_b32 s60, s60, 3
    v_xor_b32 v20, 0, v0
    v_xor_b32 v20, s60, v20
    v_lshlrev_b32 v20, 4, v20
    v_xor_b32 v21, 2, v0
    v_xor_b32 v21, s60, v21
    v_lshlrev_b32 v21, 4, v21
    v_xor_b32 v22, 4, v0
    v_xor_b32 v22, s60, v22
    v_lshlrev_b32 v22, 4, v22
    v_xor_b32 v23, 6, v0
    v_xor_b32 v23, s60, v23
    v_lshlrev_b32 v23, 4, v23
W4_18:
    ds_read_b128 v[16:19], v4 offset:80
    s_sub_u32 s53, s53, 1
    s_cbranch_scc1 L_END
    s_waitcnt lgkmcnt(0)
    v_min3_u32 v16, v16, v17, v18
    v_min_u32 v16, v16, v19
    s_nop 0
    v_readfirstlane_b32 s54, v16
    s_nop 0
    s_cmp_lt_u32 s54, 9
    s_cbranch_scc1 W4_18
    s_add_u32 s60, s62, 0
    s_and_b32 s60, s60, 3
    s_lshl_b32 s60, s60, 14
    s_add_u32 s59, s60, s58
    s_add_u32 m0, s60, s61
    s_nop 0
    buffer_load_dwordx4 v20, s[36:39], s59 offen nt lds
    s_add_u32 m0, m0, 1024
    s_add_u32 s59, s59, 1024
    buffer_load_dwordx4 v21, s[36:39], s59 offen nt lds
    s_add_u32 m0, m0, 1024
    s_add_u32 s59, s59, 1024
    buffer_load_dwordx4 v22, s[36:39], s59 offen nt lds
    s_add_u32 m0, m0, 1024
    s_add_u32 s59, s59, 1024
    buffer_load_dwordx4 v23, s[36:39], s59 offen nt lds
    s_add_u32 s60, s62, 1
    s_and_b32 s60, s60, 3
    s_lshl_b32 s60, s60, 14
    s_add_u32 s59, s60, s58
    s_add_u32 m0, s60, s61
    s_nop 0
    buffer_load_dwordx4 v20, s[36:39], s59 offen nt lds
    s_add_u32 m0, m0, 1024
    s_add_u32 s59, s59, 1024
    buffer_load_dwordx4 v21, s[36:39], s59 offen nt lds
    s_add_u32 m0, m0, 1024
    s_add_u32 s59, s59, 1024
    buffer_load_dwordx4 v22, s[36:39], s59 offen nt lds
    s_add_u32 m0, m0, 1024
    s_add_u32 s59, s59, 1024
    buffer_load_dwordx4 v23, s[36:39], s59 offen nt lds
    s_add_u32 s60, s62, 2
    s_and_b32 s60, s60, 3
    s_lshl_b32 s60, s60, 14
    s_add_u32 s59, s60, s58
    s_add_u32 m0, s60, s61
    s_nop 0
    buffer_load_dwordx4 v20, s[36:39], s59 offen nt lds
    s_add_u32 m0, m0, 1024
    s_add_u32 s59, s59, 1024
    buffer_load_dwordx4 v21, s[36:39], s59 offen nt lds
    s_add_u32 m0, m0, 1024
    s_add_u32 s59, s59, 1024
    buffer_load_dwordx4 v22, s[36:39], s59 offen nt lds
    s_add_u32 m0, m0, 1024
    s_add_u32 s59, s59, 1024
    buffer_load_dwordx4 v23, s[36:39], s59 offen nt lds
    s_add_u32 s60, s62, 3
    s_and_b32 s60, s60, 3
    s_lshl_b32 s60, s60, 14
    s_add_u32 s59, s60, s58
    s_add_u32 m0, s60, s61
    s_nop 0
    buffer_load_dwordx4 v20, s[36:39], s59 offen nt lds
    s_add_u32 m0, m0, 1024
    s_add_u32 s59, s59, 1024
    buffer_load_dwordx4 v21, s[36:39], s59 offen nt lds
    s_add_u32 m0, m0, 1024
    s_add_u32 s59, s59, 1024
    buffer_load_dwordx4 v22, s[36:39], s59 offen nt lds
    s_add_u32 m0, m0, 1024
    s_add_u32 s59, s59, 1024
    buffer_load_dwordx4 v23, s[36:39], s59 offen nt lds
    s_waitcnt vmcnt(0)
    ds_write_b32 v7, v5 offset:144
    s_mul_i32 s60, s3, 8
    v_bfe_u32 v16, v0, 2, 2
    v_and_b32 v17, 1, v2
    v_lshl_add_u32 v17, v17, 2, v16
    v_lshlrev_b32 v17, 1, v17
    v_bfe_u32 v20, v0, 1, 1
    v_xor_b32 v17, v17, v20
    v_xor_b32 v17, s60, v17
    v_lshl_add_u32 v16, v2, 3, v16
    v_mul_u32_u24 v16, 1024, v16
    v_lshl_add_u32 v16, v17, 4, v16
    v_and_b32 v17, 1, v0
    v_lshl_add_u32 v20, v17, 3, v16
    v_bfe_u32 v16, v0, 2, 2
    v_and_b32 v17, 1, v2
    v_lshl_add_u32 v17, v17, 2, v16
    v_lshlrev_b32 v17, 1, v17
    v_bfe_u32 v21, v0, 1, 1
    v_xor_b32 v17, v17, v21
    v_xor_b32 v17, s60, v17
    v_xor_b32 v17, 2, v17
    v_lshl_add_u32 v16, v2, 3, v16
    v_mul_u32_u24 v16, 1024, v16
    v_lshl_add_u32 v16, v17, 4, v16
    v_and_b32 v17, 1, v0
    v_lshl_add_u32 v21, v17, 3, v16
    v_bfe_u32 v16, v0, 2, 2
    v_and_b32 v17, 1, v2
    v_lshl_add_u32 v17, v17, 2, v16
    v_lshlrev_b32 v17, 1, v17
    v_bfe_u32 v22, v0, 1, 1
    v_xor_b32 v17, v17, v22
    v_xor_b32 v17, s60, v17
    v_xor_b32 v17, 4, v17
    v_lshl_add_u32 v16, v2, 3, v16
    v_mul_u32_u24 v16, 1024, v16
    v_lshl_add_u32 v16, v17, 4, v16
    v_and_b32 v17, 1, v0
    v_lshl_add_u32 v22, v17, 3, v16
    v_bfe_u32 v16, v0, 2, 2
    v_and_b32 v17, 1, v2
    v_lshl_add_u32 v17, v17, 2, v16
    v_lshlrev_b32 v17, 1, v17
    v_bfe_u32 v23, v0, 1, 1
    v_xor_b32 v17, v17, v23
    v_xor_b32 v17, s60, v17
    v_xor_b32 v17, 6, v17
    v_lshl_add_u32 v16, v2, 3, v16
    v_mul_u32_u24 v16, 1024, v16
    v_lshl_add_u32 v16, v17, 4, v16
    v_and_b32 v17, 1, v0
    v_lshl_add_u32 v23, v17, 3, v16
    v_and_b32 v16, 1, v0
    v_mul_u32_u24 v234, 144, v16
    v_lshl_add_u32 v234, v2, 4, v234
    v_add_u32 v234, 136448, v234
    s_mov_b32 s94, 0xcccccccc
    s_mov_b32 s95, 0xcccccccc
    s_mov_b32 s96, 0xf0f0f0f0
    s_mov_b32 s97, 0xf0f0f0f0
    s_mov_b32 s98, 0xff00ff00
    s_mov_b32 s99, 0xff00ff00
    v_mov_b32 v161, s52
    s_mov_b32 s44, s82
    s_and_b32 s45, s83, 0xffff
    s_mov_b32 s46, 1024
    s_mov_b32 s47, 0x20000
    s_mov_b32 s48, s84
    s_and_b32 s49, s85, 0xffff
    s_mov_b32 s50, 8192
    s_mov_b32 s51, 0x20000
    s_mul_i32 s60, s3, 544
    s_add_u32 s60, s60, 137600
    v_and_b32 v16, 1, v0
    v_mul_u32_u24 v52, 272, v16
    v_bfe_u32 v17, v0, 1, 2
    v_lshl_add_u32 v52, v17, 6, v52
    v_lshl_add_u32 v52, v2, 4, v52
    v_add_u32 v52, s60, v52
    v_lshrrev_b32 v16, 5, v0
    v_bfe_u32 v17, v0, 2, 3
    v_and_b32 v18, 3, v0
    v_lshl_add_u32 v17, v17, 3, v18
    v_mul_u32_u24 v19, 272, v16
    v_lshl_add_u32 v19, v17, 2, v19
    v_add_u32 v19, s60, v19
    v_mov_b32 v56, 147616
    v_mov_b32 v57, 147620
    v_cmp_eq_u32 s[68:69], 3, v18
    v_cmp_eq_u32 s[70:71], 2, v18
    v_add_u32 v53, 0, v19
    v_cndmask_b32 v53, v53, v56, s[68:69]
    v_add_u32 v54, 12, v19
    v_cndmask_b32 v54, v54, v56, s[68:69]
    v_add_u32 v55, 24, v19
    v_cndmask_b32 v55, v55, v56, s[68:69]
    v_cndmask_b32 v55, v55, v57, s[70:71]
    s_not_b64 s[68:69], s[68:69]
    s_andn2_b64 s[70:71], s[68:69], s[70:71]
    s_and_b32 s60, s62, 0
    s_mul_i32 s60, s60, 1024
    s_mul_i32 s72, s3, 128
    s_add_u32 s60, s60, s72
    v_mul_u32_u24 v56, 3072, v16
    v_and_b32 v57, 31, v0
    v_lshl_add_u32 v56, v57, 2, v56
    s_lshr_b32 s72, s62, 0
    s_mul_i32 s64, s72, 6144
    s_add_u32 s64, s64, s60
    s_add_u32 s64, s64, 229376
    v_lshl_add_u32 v57, v17, 1, s60
    v_lshl_add_u32 v58, v16, 10, v57
    v_mul_u32_u24 v59, 1040, v16
    v_add3_u32 v59, v59, v57, v4
    s_lshl_b32 s72, s72, 11
    buffer_load_ushort v60, v57, s[44:47], 0 offen offset:0
    buffer_load_ushort v61, v57, s[44:47], 0 offen offset:6
    buffer_load_ushort v62, v57, s[44:47], 0 offen offset:12
W4_19:
    ds_read_b128 v[16:19], v4 offset:144
    s_sub_u32 s53, s53, 1
    s_cbranch_scc1 L_END
    s_waitcnt lgkmcnt(0)
    v_min3_u32 v16, v16, v17, v18
    v_min_u32 v16, v16, v19
    s_nop 0
    v_readfirstlane_b32 s54, v16
    s_sleep 1
    s_cmp_lt_u32 s54, 1
    s_cbranch_scc1 W4_19
    ds_read_b64_tr_b16 v[128:129], v20 offset:0
    ds_read_b64_tr_b16 v[130:131], v20 offset:4096
    ds_read_b64_tr_b16 v[132:133], v20 offset:32768
    ds_read_b64_tr_b16 v[134:135], v20 offset:36864
    ds_read_b64_tr_b16 v[136:137], v21 offset:0
    ds_read_b64_tr_b16 v[138:139], v21 offset:4096
    ds_read_b64_tr_b16 v[140:141], v21 offset:32768
    ds_read_b64_tr_b16 v[142:143], v21 offset:36864
    s_waitcnt lgkmcnt(0)
    ds_read_b64_tr_b16 v[144:145], v22 offset:0
    ds_read_b64_tr_b16 v[146:147], v22 offset:4096
    ds_read_b64_tr_b16 v[148:149], v22 offset:32768
    ds_read_b64_tr_b16 v[150:151], v22 offset:36864
    ds_read_b64_tr_b16 v[152:153], v23 offset:0
    ds_read_b64_tr_b16 v[154:155], v23 offset:4096
    ds_read_b64_tr_b16 v[156:157], v23 offset:32768
    ds_read_b64_tr_b16 v[158:159], v23 offset:36864
    s_waitcnt lgkmcnt(0)
    s_cmp_ge_u32 s7, 2
    s_cbranch_scc1 L_MLP_W2B
    s_setprio 3
    s_mul_i32 s60, s66, 3072
    s_add_u32 s60, s60, 32768
    s_mov_b32 s61, 0x42000000
    v_lshlrev_b32 v16, 16, v8
    v_and_b32 v17, 0xffff0000, v8
    v_lshlrev_b32 v18, 16, v9
    v_and_b32 v19, 0xffff0000, v9
    v_lshlrev_b32 v20, 16, v10
    v_and_b32 v21, 0xffff0000, v10
    v_lshlrev_b32 v22, 16, v11
    v_and_b32 v23, 0xffff0000, v11
    s_mul_i32 s58, s7, 1040
    s_add_u32 s58, s58, 148096
    v_add_u32 v13, s58, v12
    s_lshl_b32 s58, s7, 4
    v_add_u32 v14, s58, v4
    s_cmp_lg_u32 s7, 0
    s_cbranch_scc1 L_V_GOW
    v_lshlrev_b32 v48, 7, v0
    s_mov_b32 s58, 65536
    s_mov_b32 s59, 73728
FL_20:
    buffer_load_dword v49, v48, s[8:11], s58 offen sc1
    buffer_load_dword v50, v48, s[8:11], s59 offen sc1
    s_sub_u32 s53, s53, 1
    s_cbranch_scc1 L_END
    s_waitcnt vmcnt(0)
    v_cmp_eq_u32 vcc, s52, v49
    v_cmp_eq_u32 s[56:57], s52, v50
    s_nop 0
    s_and_b64 vcc, vcc, s[56:57]
    s_cmp_eq_u64 vcc, -1
    s_cbranch_scc1 FL_20_ok
    s_sleep 2
    s_branch FL_20
FL_20_ok:
    ds_write_b32 v4, v5 offset:8
    s_branch L_V_GO
L_V_GOW:
W1_21:
    ds_read_b32 v48, v4 offset:8
    s_sub_u32 s53, s53, 1
    s_cbranch_scc1 L_END
    s_waitcnt lgkmcnt(0)
    v_readfirstlane_b32 s54, v48
    s_nop 0
    s_cmp_eq_u32 s54, 0
    s_cbranch_scc1 W1_21
L_V_GO:
MH_22:
    buffer_load_dwordx4 v[24:27], v12, s[8:11], s60 offen offset:0 sc1
    buffer_load_dwordx4 v[28:31], v12, s[8:11], s60 offen offset:1024 sc1
    buffer_load_dwordx4 v[32:35], v12, s[8:11], s60 offen offset:2048 sc1
    s_sub_u32 s53, s53, 1
    s_cbranch_scc1 L_END
    s_waitcnt vmcnt(2)
    v_cmp_eq_f32 s[56:57], s61, v27
    s_waitcnt vmcnt(1)
    v_cmp_eq_f32 vcc, s61, v31
    s_nop 0
    s_and_b64 s[56:57], s[56:57], vcc
    s_waitcnt vmcnt(0)
    v_cmp_eq_f32 vcc, s61, v35
    s_nop 0
    s_and_b64 s[56:57], s[56:57], vcc
    s_cmp_eq_u64 s[56:57], -1
    s_cbranch_scc1 MH_22_ok
    s_sleep 4
    s_branch MH_22
MH_22_ok:
    v_cvt_pk_bf16_f32 v36, v24, v25
    v_cvt_pk_bf16_f32 v37, v26, v28
    v_cvt_pk_bf16_f32 v38, v29, v30
    v_cvt_pk_bf16_f32 v39, v32, v33
    v_lshlrev_b32 v24, 16, v36
    v_and_b32 v25, 0xffff0000, v36
    v_lshlrev_b32 v26, 16, v37
    v_and_b32 v27, 0xffff0000, v37
    v_lshlrev_b32 v28, 16, v38
    v_and_b32 v29, 0xffff0000, v38
    v_lshlrev_b32 v30, 16, v39
    v_and_b32 v31, 0xffff0000, v39
    v_pk_add_f32 v[24:25], v[24:25], v[16:17]
    v_pk_add_f32 v[26:27], v[26:27], v[18:19]
    v_pk_add_f32 v[28:29], v[28:29], v[20:21]
    v_pk_add_f32 v[30:31], v[30:31], v[22:23]
    v_cvt_pk_bf16_f32 v44, v24, v25
    v_cvt_pk_bf16_f32 v45, v26, v27
    v_cvt_pk_bf16_f32 v46, v28, v29
    v_cvt_pk_bf16_f32 v47, v30, v31
    ds_write_b128 v13, v[44:47]
    s_waitcnt lgkmcnt(0)
    s_barrier
    v_lshlrev_b32 v24, 16, v44
    v_and_b32 v25, 0xffff0000, v44
    v_lshlrev_b32 v26, 16, v45
    v_and_b32 v27, 0xffff0000, v45
    v_lshlrev_b32 v28, 16, v46
    v_and_b32 v29, 0xffff0000, v46
    v_lshlrev_b32 v30, 16, v47
    v_and_b32 v31, 0xffff0000, v47
    v_readfirstlane_b32 s55, v24
    s_nop 1
    v_mov_b32 v42, s55
    v_mov_b32 v43, s55
    v_pk_add_f32 v[32:33], v[24:25], v[42:43] neg_lo:[0,1] neg_hi:[0,1]
    v_pk_add_f32 v[34:35], v[26:27], v[42:43] neg_lo:[0,1] neg_hi:[0,1]
    v_pk_add_f32 v[36:37], v[28:29], v[42:43] neg_lo:[0,1] neg_hi:[0,1]
    v_pk_add_f32 v[38:39], v[30:31], v[42:43] neg_lo:[0,1] neg_hi:[0,1]
    v_pk_add_f32 v[40:41], v[32:33], v[34:35]
    v_pk_mul_f32 v[42:43], v[32:33], v[32:33]
    v_pk_add_f32 v[32:33], v[36:37], v[38:39]
    v_pk_fma_f32 v[42:43], v[34:35], v[34:35], v[42:43]
    v_pk_fma_f32 v[42:43], v[36:37], v[36:37], v[42:43]
    v_pk_fma_f32 v[42:43], v[38:39], v[38:39], v[42:43]
    v_pk_add_f32 v[40:41], v[40:41], v[32:33]
    v_add_f32 v42, v42, v43
    v_add_f32 v40, v40, v41
    s_nop 1
    v_add_f32_dpp v40, v40, v40 quad_perm:[1,0,3,2] row_mask:0xf bank_mask:0xf
    v_add_f32_dpp v42, v42, v42 quad_perm:[1,0,3,2] row_mask:0xf bank_mask:0xf
    s_nop 0
    v_add_f32_dpp v40, v40, v40 quad_perm:[2,3,0,1] row_mask:0xf bank_mask:0xf
    v_add_f32_dpp v42, v42, v42 quad_perm:[2,3,0,1] row_mask:0xf bank_mask:0xf
    s_nop 0
    v_add_f32_dpp v40, v40, v40 row_half_mirror row_mask:0xf bank_mask:0xf
    v_add_f32_dpp v42, v42, v42 row_half_mirror row_mask:0xf bank_mask:0xf
    s_nop 0
    v_add_f32_dpp v40, v40, v40 row_mirror row_mask:0xf bank_mask:0xf
    v_add_f32_dpp v42, v42, v42 row_mirror row_mask:0xf bank_mask:0xf
    s_nop 0
    v_add_f32_dpp v40, v40, v40 row_bcast:15 row_mask:0xa bank_mask:0xf
    v_add_f32_dpp v42, v42, v42 row_bcast:15 row_mask:0xa bank_mask:0xf
    s_nop 0
    v_add_f32_dpp v40, v40, v40 row_bcast:31 row_mask:0xc bank_mask:0xf
    v_add_f32_dpp v42, v42, v42 row_bcast:31 row_mask:0xc bank_mask:0xf
    v_readlane_b32 s56, v40, 63
    v_readlane_b32 s57, v42, 63
    v_mov_b32 v34, 0x3b000000
    v_mul_f32 v32, s56, v34
    v_mul_f32 v33, s57, v34
    v_fma_f32 v33, -v32, v32, v33
    v_max_f32 v33, 0, v33
    v_add_f32 v32, s55, v32
    v_mov_b32 v34, v32
    v_mov_b32 v35, v33
    v_cvt_pk_bf16_f32 v36, v34, v35
    v_lshlrev_b32 v34, 16, v36
    v_and_b32 v35, 0xffff0000, v36
    v_add_f32 v35, 0x3727c5ac, v35
    v_cvt_pk_bf16_f32 v36, v35, v35
    v_lshlrev_b32 v35, 16, v36
    v_sqrt_f32 v35, v35
    s_nop 0
    v_cvt_pk_bf16_f32 v36, v35, v35
    v_lshlrev_b32 v35, 16, v36
    v_rcp_f32 v36, v35
    s_nop 0
    v_fma_f32 v37, -v35, v36, 1.0
    v_fma_f32 v36, v37, v36, v36
    v_sub_f32 v32, v32, v34
    v_mul_f32 v32, v32, v36
    v_mul_f32 v33, v33, v36
    v_mul_f32 v33, v33, v36
    v_cvt_pk_bf16_f32 v37, v32, v33
    v_lshlrev_b32 v32, 16, v37
    v_and_b32 v33, 0xffff0000, v37
    v_add_f32 v33, 0x3727c5ac, v33
    v_cvt_pk_bf16_f32 v37, v33, v33
    v_lshlrev_b32 v33, 16, v37
    v_sqrt_f32 v33, v33
    s_nop 0
    v_cvt_pk_bf16_f32 v37, v33, v33
    v_lshlrev_b32 v33, 16, v37
    v_rcp_f32 v37, v33
    s_nop 0
    v_fma_f32 v38, -v33, v37, 1.0
    v_fma_f32 v37, v38, v37, v37
    v_mul_f32 v40, v36, v37
    v_fma_f32 v41, v32, v35, v34
    v_mul_f32 v41, -v41, v40
    v_mov_b32 v42, 1
    ds_write_b96 v14, v[40:42] offset:176
    s_branch L_MLP_W2
L_FIN:
L_END:
    s_endpgm

.section .rodata,"a"
.p2align 6
.amdhsa_kernel sequential_preLN__sliding_block_cached__mixer_channel_mlp__decode_kernel
  .amdhsa_next_free_vgpr 256
  .amdhsa_next_free_sgpr 102
  .amdhsa_accum_offset 256
  .amdhsa_group_segment_fixed_size 0
  .amdhsa_kernarg_size 104
  .amdhsa_user_sgpr_count 2
  .amdhsa_user_sgpr_kernarg_segment_ptr 1
  .amdhsa_system_sgpr_workgroup_id_x 1
  .amdhsa_float_denorm_mode_32 3
.end_amdhsa_kernel
```
